```python
import torch

def _softmax(x, axis=-1):
    return torch.softmax(x, dim=axis)
def _gelu(x):
    return torch.nn.functional.gelu(x, approximate="tanh")
def _silu(x):
    return torch.nn.functional.silu(x)
def _sigmoid(x):
    return torch.sigmoid(x)
def _layernorm(x, axis=-1, eps=1e-5):
    m = x.mean(dim=axis, keepdim=True)
    v = x.var(dim=axis, keepdim=True, unbiased=False)
    return (x - m) / torch.sqrt(v + eps)
def _scatter_add(tgt, idx, src, axis=0):
    return tgt.clone().index_add_(axis, idx, src)
def _segment_sum(src, seg, n):
    out = torch.zeros((n,) + src.shape[1:], dtype=src.dtype)
    return out.index_add_(0, seg, src)
def _pad(x, pw):
    flat = tuple(v for pair in reversed(pw) for v in pair)
    return torch.nn.functional.pad(x, flat)

kernel_name = 'gated_mix__spectral_gfnet__mixer_token_mlp__prompt'

def setup_inputs():

    _w = (lambda a: (lambda t: t.to(torch.bfloat16) if t.is_floating_point() else t)(torch.as_tensor(a)))
    def _A_setup():
        B, S, D = 1, 2048, 640
        Df = D // 2 + 1
        return {
            "x": _w((lambda *s: torch.randn(*s, dtype=torch.bfloat16) * 0.05)(B, S, D)),
            "w_r": _w((lambda *s: torch.randn(*s, dtype=torch.bfloat16) * 0.8)(S, Df) * 0.02),
            "w_i": _w((lambda *s: torch.randn(*s, dtype=torch.bfloat16) * 0.8)(S, Df) * 0.02),
        }
    _A_in = _A_setup()

    def _B_setup():
        B, S, D, F = 1, 2048, 640, 1728
        return {
            "x": _w((lambda *s: torch.randn(*s, dtype=torch.bfloat16) * 0.05)(B, S, D)),
            "w1": _w((lambda *s: torch.randn(*s, dtype=torch.bfloat16) * 0.2)(S, F) * (S ** -0.5)),
            "b1": _w((lambda *s: torch.randn(*s, dtype=torch.bfloat16) * 3.2)(F) * 0.02),
            "w2": _w((lambda *s: torch.randn(*s, dtype=torch.bfloat16) * 0.05)(F, S) * (F ** -0.5)),
            "b2": _w((lambda *s: torch.randn(*s, dtype=torch.bfloat16) * 0.1)(S) * 0.02),
        }
    _B_in = _B_setup()

    return {
        "A_x": _A_in["x"],
        "A_w_r": _A_in["w_r"],
        "A_w_i": _A_in["w_i"],
        "B_x": _B_in["x"],
        "B_w1": _B_in["w1"],
        "B_b1": _B_in["b1"],
        "B_w2": _B_in["w2"],
        "B_b2": _B_in["b2"],
        "gate_w": _w((lambda *s: torch.randn(*s, dtype=torch.bfloat16) * 0.05)(640) * 16.0),
    }

def reference(A_x, A_w_r, A_w_i, B_x, B_w1, B_b1, B_w2, B_b2, gate_w):
    def _A_ref(x, w_r, w_i):
        B, S, D = x.shape
        X = (lambda x, axes=(-2,-1): torch.fft.rfft2(x.float(), dim=axes))(x, axes=(-2, -1))
        W = w_r + 1j * w_i
        X = X * W
        y = (lambda x, s, axes=(-2,-1): torch.fft.irfft2(x, s=s, dim=axes).to(torch.bfloat16))(X, (S, D), axes=(-2, -1))
        return y

    def _B_ref(x, w1, b1, w2, b2):
        B, S, D = x.shape
        h = _layernorm(x, axis=-1)
        u = torch.einsum("bsd,sf->bdf", h, w1) + b1
        u = _gelu(u)
        y = torch.einsum("bdf,fs->bds", u, w2) + b2
        return (lambda x, *d: x.permute(*d))(y, 0, 2, 1)

    x = A_x
    g = _sigmoid((x * gate_w).sum(-1, keepdims=True))
    a = _A_ref(x, A_w_r, A_w_i)
    b = _B_ref(x, B_w1, B_b1, B_w2, B_b2)
    return g * a + (1 - g) * b
```

```asm
; @launch grid=(256,1,1) block=(512,1,1) lds=163840
.amdgcn_target "amdgcn-amd-amdhsa--gfx950"
.text
.globl gated_mix__spectral_gfnet__mixer_token_mlp__prompt_kernel
.p2align 8
.type gated_mix__spectral_gfnet__mixer_token_mlp__prompt_kernel,@function
gated_mix__spectral_gfnet__mixer_token_mlp__prompt_kernel:
    s_cmp_ge_u32 s2, 256
    s_cbranch_scc1 K_end
    s_load_dwordx16 s[64:79], s[0:1], 0
    s_load_dwordx8 s[80:87], s[0:1], 64
    v_and_b32 v1, 63, v0
    v_lshrrev_b32 v2, 6, v0
    s_nop 0
    v_readfirstlane_b32 s3, v2
    v_and_b32 v2, 15, v0
    v_bfe_u32 v3, v0, 4, 2
    s_and_b32 s56, s2, 7
    s_lshr_b32 s57, s2, 3
    s_cmp_lt_u32 s56, 3
    s_cselect_b32 s59, 32, 24
    s_cmp_ge_u32 s57, s59
    s_cselect_b32 s32, 1, 0
    s_and_b32 s33, s57, 7
    s_lshr_b32 s60, s57, 3
    s_lshl_b32 s60, s60, 3
    s_add_u32 s34, s60, s56
    s_sub_u32 s60, s56, 3
    s_lshl_b32 s60, s60, 3
    s_add_u32 s60, s60, s57
    s_sub_u32 s35, s60, 24
    s_lshl_b32 s60, s56, 2
    s_and_b32 s61, s57, 3
    s_add_u32 s37, s60, s61
    s_lshr_b32 s36, s57, 2
    s_waitcnt lgkmcnt(0)
    s_mov_b32 s16, s86
    s_and_b32 s17, s87, 0xffff
    s_mov_b32 s18, 0xd02000
    s_mov_b32 s19, 0x20000
    s_or_b32 s60, s2, s3
    s_cmp_eq_u32 s60, 0
    s_cbranch_scc0 K_nononce
    s_memrealtime s[60:61]
    s_waitcnt lgkmcnt(0)
    s_or_b32 s61, s61, 0x40000000
    v_mov_b32 v10, s60
    v_mov_b32 v11, s61
    v_mov_b32 v12, 0
    s_mov_b64 s[22:23], exec
    s_mov_b64 exec, 1
    global_store_dwordx2 v12, v[10:11], s[84:85] sc1
    s_mov_b64 exec, s[22:23]
K_nononce:
    s_lshl_b32 s96, s2, 3
    s_add_u32 s97, s96, s3
    s_mul_i32 s98, s97, 1280
    s_mov_b32 s8, s64
    s_and_b32 s9, s65, 0xffff
    s_mov_b32 s10, 0x280000
    s_mov_b32 s11, 0x20000
    s_mov_b32 s12, s80
    s_and_b32 s13, s81, 0xffff
    s_mov_b32 s14, 0x500
    s_mov_b32 s15, 0x20000
    v_lshlrev_b32 v10, 2, v1
    buffer_load_dword v11, v10, s[8:11], s98 offen offset:0 nt
    buffer_load_dword v12, v10, s[8:11], s98 offen offset:256 nt
    buffer_load_dword v13, v10, s[8:11], s98 offen offset:512 nt
    buffer_load_dword v14, v10, s[8:11], s98 offen offset:768 nt
    buffer_load_dword v15, v10, s[8:11], s98 offen offset:1024 nt
    buffer_load_dword v16, v10, s[12:15], 0 offen offset:0
    buffer_load_dword v17, v10, s[12:15], 0 offen offset:256
    buffer_load_dword v18, v10, s[12:15], 0 offen offset:512
    buffer_load_dword v19, v10, s[12:15], 0 offen offset:768
    buffer_load_dword v20, v10, s[12:15], 0 offen offset:1024
    s_mov_b32 s24, s66
    s_and_b32 s25, s67, 0xffff
    s_mov_b32 s26, 0x141000
    s_mov_b32 s27, 0x20000
    s_mov_b32 s28, s68
    s_and_b32 s29, s69, 0xffff
    s_mov_b32 s30, 0x141000
    s_mov_b32 s31, 0x20000
    v_lshlrev_b32 v33, 1, v1
    s_mul_i32 s99, s97, 642
    buffer_load_ushort v21, v33, s[24:27], s99 offen offset:0 nt
    buffer_load_ushort v26, v33, s[28:31], s99 offen offset:0 nt
    buffer_load_ushort v22, v33, s[24:27], s99 offen offset:128 nt
    buffer_load_ushort v27, v33, s[28:31], s99 offen offset:128 nt
    buffer_load_ushort v23, v33, s[24:27], s99 offen offset:256 nt
    buffer_load_ushort v28, v33, s[28:31], s99 offen offset:256 nt
    buffer_load_ushort v24, v33, s[24:27], s99 offen offset:384 nt
    buffer_load_ushort v29, v33, s[28:31], s99 offen offset:384 nt
    buffer_load_ushort v25, v33, s[24:27], s99 offen offset:512 nt
    buffer_load_ushort v30, v33, s[28:31], s99 offen offset:512 nt
    s_sub_u32 s100, 2048, s97
    s_and_b32 s100, s100, 2047
    s_mul_i32 s100, s100, 642
    v_mov_b32 v34, s99
    v_mov_b32 v35, s100
    v_and_b32 v33, 1, v1
    v_cmp_eq_u32 vcc, 1, v33
    s_nop 1
    v_cndmask_b32 v34, v34, v35, vcc
    v_bfe_u32 v33, v1, 1, 1
    v_mul_u32_u24 v33, 640, v33
    v_add_u32 v34, v34, v33
    buffer_load_ushort v31, v34, s[24:27], 0 offen
    buffer_load_ushort v32, v34, s[28:31], 0 offen
    s_getpc_b64 s[90:91]
K_pc:
    s_and_b32 s90, s90, 0xffffff00
    s_lshr_b32 s92, s2, 3
    s_lshl_b32 s92, s92, 3
    s_add_u32 s92, s92, s3
    s_lshl_b32 s92, s92, 8
    v_lshlrev_b32 v34, 2, v1
    v_add_u32 v34, s92, v34
    v_min_u32 v34, CODE_LIMIT, v34
    global_load_dword v33, v34, s[90:91]
    v_lshrrev_b32 v35, 3, v1
    v_and_b32 v36, 7, v1
    v_and_b32 v37, 2, v35
    v_xor_b32 v36, v36, v37
    v_mul_u32_u24 v35, 3456, v35
    v_lshl_add_u32 v8, v36, 4, v35
    v_xor_b32 v36, 4, v36
    v_lshl_add_u32 v9, v36, 4, v35
    v_lshrrev_b32 v35, 3, v1
    v_and_b32 v36, 7, v1
    v_and_b32 v37, 6, v35
    v_xor_b32 v36, v36, v37
    v_mul_u32_u24 v35, 4096, v35
    v_lshl_add_u32 v4, v36, 4, v35
    s_mul_i32 s38, s3, 12288
    s_lshl_b32 s39, s3, 12
    s_add_u32 s39, s39, 98304
    s_mov_b32 s4, s72
    s_and_b32 s5, s73, 0xffff
    s_mov_b32 s6, 0x6c0000
    s_mov_b32 s7, 0x20000
    s_mul_i32 s59, s3, 884736
    s_lshl_b32 s58, s34, 7
    s_add_u32 s59, s59, s58
    s_add_u32 s40, s33, 0
    s_cmp_ge_u32 s40, 8
    s_cselect_b32 s61, 8, 0
    s_sub_u32 s40, s40, s61
    s_mul_i32 s40, s40, 110592
    s_add_u32 s40, s40, s59
    s_add_u32 s41, s33, 1
    s_cmp_ge_u32 s41, 8
    s_cselect_b32 s61, 8, 0
    s_sub_u32 s41, s41, s61
    s_mul_i32 s41, s41, 110592
    s_add_u32 s41, s41, s59
    s_add_u32 s42, s33, 2
    s_cmp_ge_u32 s42, 8
    s_cselect_b32 s61, 8, 0
    s_sub_u32 s42, s42, s61
    s_mul_i32 s42, s42, 110592
    s_add_u32 s42, s42, s59
    s_add_u32 s43, s33, 3
    s_cmp_ge_u32 s43, 8
    s_cselect_b32 s61, 8, 0
    s_sub_u32 s43, s43, s61
    s_mul_i32 s43, s43, 110592
    s_add_u32 s43, s43, s59
    s_add_u32 s44, s33, 4
    s_cmp_ge_u32 s44, 8
    s_cselect_b32 s61, 8, 0
    s_sub_u32 s44, s44, s61
    s_mul_i32 s44, s44, 110592
    s_add_u32 s44, s44, s59
    s_add_u32 s45, s33, 5
    s_cmp_ge_u32 s45, 8
    s_cselect_b32 s61, 8, 0
    s_sub_u32 s45, s45, s61
    s_mul_i32 s45, s45, 110592
    s_add_u32 s45, s45, s59
    s_add_u32 s46, s33, 6
    s_cmp_ge_u32 s46, 8
    s_cselect_b32 s61, 8, 0
    s_sub_u32 s46, s46, s61
    s_mul_i32 s46, s46, 110592
    s_add_u32 s46, s46, s59
    s_add_u32 s47, s33, 7
    s_cmp_ge_u32 s47, 8
    s_cselect_b32 s61, 8, 0
    s_sub_u32 s47, s47, s61
    s_mul_i32 s47, s47, 110592
    s_add_u32 s47, s47, s59
    s_mov_b32 s88, s33
    v_cvt_f32_u32 v35, v2
    v_cvt_f32_u32 v36, v3
    v_cmp_ge_u32 vcc, 10, v2
    s_nop 1
    v_cndmask_b32 v82, 0, 1.0, vcc
    v_mov_b32 v83, v82
    v_cmp_ge_u32 vcc, 2, v3
    s_nop 1
    v_cndmask_b32 v82, 0, v82, vcc
    v_cmp_ge_u32 vcc, 1, v3
    s_nop 1
    v_cndmask_b32 v83, 0, v83, vcc
    v_mul_f32 v80, 0x3d4ccccd, v35
    v_mul_f32 v81, 0x41000000, v36
    v_mul_f32 v81, v81, v80
    v_cos_f32 v84, v81
    v_sin_f32 v86, v81
    v_add_f32 v81, v81, v80
    v_cos_f32 v85, v81
    v_sin_f32 v87, v81
    v_add_f32 v81, v81, v80
    v_mul_f32 v84, v84, v82
    v_mul_f32 v85, v85, v82
    v_mul_f32_e64 v86, -v86, v82
    v_mul_f32_e64 v87, -v87, v82
    v_cvt_pk_bf16_f32 v40, v84, v85
    v_cvt_pk_bf16_f32 v44, v86, v87
    v_cos_f32 v84, v81
    v_sin_f32 v86, v81
    v_add_f32 v81, v81, v80
    v_cos_f32 v85, v81
    v_sin_f32 v87, v81
    v_add_f32 v81, v81, v80
    v_mul_f32 v84, v84, v82
    v_mul_f32 v85, v85, v82
    v_mul_f32_e64 v86, -v86, v82
    v_mul_f32_e64 v87, -v87, v82
    v_cvt_pk_bf16_f32 v41, v84, v85
    v_cvt_pk_bf16_f32 v45, v86, v87
    v_cos_f32 v84, v81
    v_sin_f32 v86, v81
    v_add_f32 v81, v81, v80
    v_cos_f32 v85, v81
    v_sin_f32 v87, v81
    v_add_f32 v81, v81, v80
    v_mul_f32 v84, v84, v83
    v_mul_f32 v85, v85, v83
    v_mul_f32_e64 v86, -v86, v83
    v_mul_f32_e64 v87, -v87, v83
    v_cvt_pk_bf16_f32 v42, v84, v85
    v_cvt_pk_bf16_f32 v46, v86, v87
    v_cos_f32 v84, v81
    v_sin_f32 v86, v81
    v_add_f32 v81, v81, v80
    v_cos_f32 v85, v81
    v_sin_f32 v87, v81
    v_add_f32 v81, v81, v80
    v_mul_f32 v84, v84, v83
    v_mul_f32 v85, v85, v83
    v_mul_f32_e64 v86, -v86, v83
    v_mul_f32_e64 v87, -v87, v83
    v_cvt_pk_bf16_f32 v43, v84, v85
    v_cvt_pk_bf16_f32 v47, v86, v87
    v_mul_f32 v80, 0x3acccccd, v35
    v_fmaak_f32 v81, 4.0, v36, 0x00000000
    v_mul_f32 v81, v81, v80
    v_cos_f32 v48, v81
    v_sin_f32 v56, v81
    v_add_f32 v81, v81, v80
    v_cos_f32 v49, v81
    v_sin_f32 v57, v81
    v_add_f32 v81, v81, v80
    v_cos_f32 v50, v81
    v_sin_f32 v58, v81
    v_add_f32 v81, v81, v80
    v_cos_f32 v51, v81
    v_sin_f32 v59, v81
    v_fmaak_f32 v81, 4.0, v36, 0x41800000
    v_mul_f32 v81, v81, v80
    v_cos_f32 v52, v81
    v_sin_f32 v60, v81
    v_add_f32 v81, v81, v80
    v_cos_f32 v53, v81
    v_sin_f32 v61, v81
    v_add_f32 v81, v81, v80
    v_cos_f32 v54, v81
    v_sin_f32 v62, v81
    v_add_f32 v81, v81, v80
    v_cos_f32 v55, v81
    v_sin_f32 v63, v81
    v_xor_b32 v56, 0x80000000, v56
    v_xor_b32 v57, 0x80000000, v57
    v_xor_b32 v58, 0x80000000, v58
    v_xor_b32 v59, 0x80000000, v59
    v_xor_b32 v60, 0x80000000, v60
    v_xor_b32 v61, 0x80000000, v61
    v_xor_b32 v62, 0x80000000, v62
    v_xor_b32 v63, 0x80000000, v63
    v_mul_f32 v80, 0x3d000000, v35
    v_fmaak_f32 v81, 4.0, v36, 0x00000000
    v_mul_f32 v81, v81, v80
    v_cos_f32 v84, v81
    v_sin_f32 v86, v81
    v_add_f32 v81, v81, v80
    v_cos_f32 v85, v81
    v_sin_f32 v87, v81
    v_add_f32 v81, v81, v80
    v_cvt_pk_bf16_f32 v64, v84, v85
    v_cvt_pk_bf16_f32 v72, -v86, -v87
    v_cos_f32 v84, v81
    v_sin_f32 v86, v81
    v_add_f32 v81, v81, v80
    v_cos_f32 v85, v81
    v_sin_f32 v87, v81
    v_add_f32 v81, v81, v80
    v_cvt_pk_bf16_f32 v65, v84, v85
    v_cvt_pk_bf16_f32 v73, -v86, -v87
    v_fmaak_f32 v81, 4.0, v36, 0x41800000
    v_mul_f32 v81, v81, v80
    v_cos_f32 v84, v81
    v_sin_f32 v86, v81
    v_add_f32 v81, v81, v80
    v_cos_f32 v85, v81
    v_sin_f32 v87, v81
    v_add_f32 v81, v81, v80
    v_cvt_pk_bf16_f32 v66, v84, v85
    v_cvt_pk_bf16_f32 v74, -v86, -v87
    v_cos_f32 v84, v81
    v_sin_f32 v86, v81
    v_add_f32 v81, v81, v80
    v_cos_f32 v85, v81
    v_sin_f32 v87, v81
    v_add_f32 v81, v81, v80
    v_cvt_pk_bf16_f32 v67, v84, v85
    v_cvt_pk_bf16_f32 v75, -v86, -v87
    v_xor_b32 v68, 0x80000000, v64
    v_xor_b32 v76, 0x80000000, v72
    v_xor_b32 v69, 0x80000000, v65
    v_xor_b32 v77, 0x80000000, v73
    v_xor_b32 v70, 0x80000000, v66
    v_xor_b32 v78, 0x80000000, v74
    v_xor_b32 v71, 0x80000000, v67
    v_xor_b32 v79, 0x80000000, v75
    s_mul_i32 s101, s3, 1344
    s_add_u32 s101, s101, 98304
    v_add_u32 v80, s101, v10
    v_lshrrev_b32 v86, 2, v2
    v_and_b32 v87, 3, v2
    v_lshl_add_u32 v88, v3, 3, v86
    v_cmp_eq_u32 vcc, 3, v3
    s_nop 1
    v_cndmask_b32 v88, v88, v86, vcc
    v_lshlrev_b32 v88, 6, v88
    v_lshl_add_u32 v88, v87, 3, v88
    v_add_u32 v81, s101, v88
    v_lshl_add_u32 v88, v3, 3, v86
    v_add_u32 v88, 4, v88
    v_cmp_le_u32 vcc, 2, v3
    s_nop 1
    v_cndmask_b32 v88, v88, v86, vcc
    v_lshlrev_b32 v88, 6, v88
    v_lshl_add_u32 v88, v87, 3, v88
    v_add_u32 v82, s101, v88
    v_mul_u32_u24 v88, 1344, v86
    v_lshl_add_u32 v88, v3, 5, v88
    v_lshl_add_u32 v88, v87, 3, v88
    s_lshl_b32 s49, s3, 7
    s_add_u32 s49, s49, 109056
    v_add_u32 v83, s49, v88
    v_mul_u32_u24 v88, 80, v3
    v_add_u32 v88, v88, v2
    s_mul_i32 s49, s3, 1296
    s_add_u32 s49, s49, 119808
    v_lshlrev_b32 v86, 2, v88
    v_add_u32 v84, s49, v86
    v_mov_b32 v87, 140544
    v_cmp_lt_u32 vcc, 10, v2
    s_nop 1
    v_cndmask_b32 v84, v84, v87, vcc
    s_add_u32 s49, s49, 1040
    v_sub_u32 v85, s49, v86
    v_cmp_le_u32 vcc, 10, v2
    s_nop 1
    v_cndmask_b32 v85, v85, v87, vcc
    v_cmp_eq_u32 vcc, 0, v2
    s_nop 1
    v_cndmask_b32 v85, v85, v87, vcc
    v_and_b32 v90, 3, v0
    v_lshrrev_b32 v91, 2, v0
    v_mul_u32_u24 v87, 2592, v90
    v_lshl_add_u32 v87, v91, 3, v87
    v_add_u32 v89, 130176, v87
    v_add_u32 v87, 119808, v87
    v_lshlrev_b32 v88, 14, v91
    v_lshl_add_u32 v88, v90, 4, v88
    v_lshlrev_b32 v86, 10, v3
    v_lshl_add_u32 v86, v2, 4, v86
    s_lshr_b32 s53, s2, 2
    s_mul_i32 s53, s53, 40960
    s_and_b32 s54, s2, 3
    s_lshl_b32 s54, s54, 8
    s_add_u32 s53, s53, s54
    s_add_u32 s53, s53, 0
    s_lshl_b32 s54, s3, 12
    s_add_u32 s54, s53, s54
    s_lshl_b32 s55, s96, 3
    s_add_u32 s55, s55, 2621440
    s_lshl_b32 s56, s96, 3
    s_add_u32 s56, s56, 5242880
    s_cmp_eq_u32 s32, 0
    s_cbranch_scc0 K_nopf
    s_lshl_b32 s63, s33, 3
    s_add_u32 s63, s63, s3
    s_mul_i32 s63, s63, 110592
    s_lshl_b32 s62, s34, 7
    s_add_u32 s63, s63, s62
    buffer_load_dwordx4 v[92:95], v8, s[4:7], s63 offen nt
    s_add_u32 s63, s63, 27648
    buffer_load_dwordx4 v[92:95], v8, s[4:7], s63 offen nt
    s_add_u32 s63, s63, 27648
    buffer_load_dwordx4 v[92:95], v8, s[4:7], s63 offen nt
    s_add_u32 s63, s63, 27648
    buffer_load_dwordx4 v[92:95], v8, s[4:7], s63 offen nt
K_nopf:
    s_cmp_eq_u32 s32, 0
    s_cbranch_scc1 K_rw_x
    s_waitcnt vmcnt(18)
K_rw_x:
    s_waitcnt vmcnt(22)
    ds_write_b32 v80, v11 offset:0
    ds_write_b32 v80, v12 offset:256
    ds_write_b32 v80, v13 offset:512
    ds_write_b32 v80, v14 offset:768
    ds_write_b32 v80, v15 offset:1024
    s_mul_i32 s51, s3, 48
    v_subrev_u32 v112, s51, v80
    s_cmp_eq_u32 s32, 0
    s_cbranch_scc1 K_rw_w
    s_waitcnt vmcnt(3)
K_rw_w:
    s_waitcnt vmcnt(7)
    v_lshl_or_b32 v108, v26, 16, v21
    ds_write_b32 v112, v108 offset:31872
    v_lshl_or_b32 v108, v27, 16, v22
    ds_write_b32 v112, v108 offset:32128
    v_lshl_or_b32 v108, v28, 16, v23
    ds_write_b32 v112, v108 offset:32384
    v_lshl_or_b32 v108, v29, 16, v24
    ds_write_b32 v112, v108 offset:32640
    v_lshl_or_b32 v108, v30, 16, v25
    ds_write_b32 v112, v108 offset:32896
    s_waitcnt lgkmcnt(0)
    s_barrier
    ds_read2_b64 v[116:119], v89 offset0:0 offset1:162
    s_cmp_lt_u32 s3, 2
    s_cbranch_scc0 K_p1skipw
    v_add_u32 v110, 1024, v89
    ds_read2_b64 v[120:123], v110 offset0:0 offset1:162
    s_add_u32 s59, s56, 2097152
    s_waitcnt lgkmcnt(0)
    buffer_store_dwordx4 v[120:123], v88, s[16:19], s59 offen sc1
K_p1skipw:
    s_waitcnt lgkmcnt(0)
    buffer_store_dwordx4 v[116:119], v88, s[16:19], s56 offen sc1
    v_mov_b32 v111, 0
    global_load_dwordx2 v[6:7], v111, s[84:85] sc1
    s_mov_b32 s49, 0x3f803f80
    v_mov_b32 v106, 0
    v_mov_b32 v107, 0
    s_waitcnt lgkmcnt(0)
    ds_read_b64_tr_b16 v[124:125], v81 offset:0
    ds_read_b64_tr_b16 v[126:127], v82 offset:0
    ds_read_b64_tr_b16 v[128:129], v81 offset:32
    ds_read_b64_tr_b16 v[130:131], v82 offset:32
    v_dot2_f32_bf16 v106, v11, s49, v106
    v_dot2_f32_bf16 v106, v12, s49, v106
    v_dot2_f32_bf16 v106, v13, s49, v106
    v_dot2_f32_bf16 v106, v14, s49, v106
    v_dot2_f32_bf16 v106, v15, s49, v106
    v_dot2_f32_bf16 v107, v11, v16, v107
    v_dot2_f32_bf16 v107, v12, v17, v107
    v_dot2_f32_bf16 v107, v13, v18, v107
    v_dot2_f32_bf16 v107, v14, v19, v107
    v_dot2_f32_bf16 v107, v15, v20, v107
    v_lshlrev_b32 v96, 16, v11
    v_and_b32 v97, 0xffff0000, v11
    v_lshlrev_b32 v98, 16, v12
    v_and_b32 v99, 0xffff0000, v12
    v_lshlrev_b32 v100, 16, v13
    v_and_b32 v101, 0xffff0000, v13
    v_lshlrev_b32 v102, 16, v14
    v_and_b32 v103, 0xffff0000, v14
    v_lshlrev_b32 v104, 16, v15
    v_and_b32 v105, 0xffff0000, v15
    s_waitcnt lgkmcnt(0)
    v_mfma_f32_16x16x32_bf16 v[132:135], v[124:127], v[40:43], 0
    v_mfma_f32_16x16x32_bf16 v[140:143], v[124:127], v[44:47], 0
    v_mfma_f32_16x16x32_bf16 v[136:139], v[128:131], v[40:43], 0
    v_mfma_f32_16x16x32_bf16 v[144:147], v[128:131], v[44:47], 0
    v_add_f32_dpp v106, v106, v106 row_shr:1 row_mask:0xf bank_mask:0xf bound_ctrl:0
    v_add_f32_dpp v107, v107, v107 row_shr:1 row_mask:0xf bank_mask:0xf bound_ctrl:0
    s_nop 0
    v_add_f32_dpp v106, v106, v106 row_shr:2 row_mask:0xf bank_mask:0xf bound_ctrl:0
    v_add_f32_dpp v107, v107, v107 row_shr:2 row_mask:0xf bank_mask:0xf bound_ctrl:0
    s_nop 0
    v_add_f32_dpp v106, v106, v106 row_shr:4 row_mask:0xf bank_mask:0xf bound_ctrl:0
    v_add_f32_dpp v107, v107, v107 row_shr:4 row_mask:0xf bank_mask:0xf bound_ctrl:0
    s_nop 0
    v_add_f32_dpp v106, v106, v106 row_shr:8 row_mask:0xf bank_mask:0xf bound_ctrl:0
    v_add_f32_dpp v107, v107, v107 row_shr:8 row_mask:0xf bank_mask:0xf bound_ctrl:0
    s_nop 0
    v_add_f32_dpp v106, v106, v106 row_bcast:15 row_mask:0xa bank_mask:0xf
    v_add_f32_dpp v107, v107, v107 row_bcast:15 row_mask:0xa bank_mask:0xf
    s_nop 0
    v_add_f32_dpp v106, v106, v106 row_bcast:31 row_mask:0xc bank_mask:0xf
    v_add_f32_dpp v107, v107, v107 row_bcast:31 row_mask:0xc bank_mask:0xf
    v_readlane_b32 s49, v106, 63
    v_readlane_b32 s50, v107, 63
    v_pk_mul_f32 v[148:149], v[132:133], v[48:49]
    v_pk_mul_f32 v[156:157], v[132:133], v[56:57]
    v_pk_mul_f32 v[150:151], v[134:135], v[50:51]
    v_pk_mul_f32 v[158:159], v[134:135], v[58:59]
    v_pk_mul_f32 v[152:153], v[136:137], v[52:53]
    v_pk_mul_f32 v[160:161], v[136:137], v[60:61]
    v_pk_mul_f32 v[154:155], v[138:139], v[54:55]
    v_pk_mul_f32 v[162:163], v[138:139], v[62:63]
    v_pk_fma_f32 v[148:149], v[140:141], v[56:57], v[148:149] neg_lo:[1,0,0] neg_hi:[1,0,0]
    v_pk_fma_f32 v[156:157], v[140:141], v[48:49], v[156:157]
    v_pk_fma_f32 v[150:151], v[142:143], v[58:59], v[150:151] neg_lo:[1,0,0] neg_hi:[1,0,0]
    v_pk_fma_f32 v[158:159], v[142:143], v[50:51], v[158:159]
    v_pk_fma_f32 v[152:153], v[144:145], v[60:61], v[152:153] neg_lo:[1,0,0] neg_hi:[1,0,0]
    v_pk_fma_f32 v[160:161], v[144:145], v[52:53], v[160:161]
    v_pk_fma_f32 v[154:155], v[146:147], v[62:63], v[154:155] neg_lo:[1,0,0] neg_hi:[1,0,0]
    v_pk_fma_f32 v[162:163], v[146:147], v[54:55], v[162:163]
    v_cvt_pk_bf16_f32 v164, v148, v149
    v_cvt_pk_bf16_f32 v168, v156, v157
    v_cvt_pk_bf16_f32 v165, v150, v151
    v_cvt_pk_bf16_f32 v169, v158, v159
    v_cvt_pk_bf16_f32 v166, v152, v153
    v_cvt_pk_bf16_f32 v170, v160, v161
    v_cvt_pk_bf16_f32 v167, v154, v155
    v_cvt_pk_bf16_f32 v171, v162, v163
    v_xor_b32 v172, 0x80008000, v168
    v_xor_b32 v173, 0x80008000, v169
    v_xor_b32 v174, 0x80008000, v170
    v_xor_b32 v175, 0x80008000, v171
    v_mfma_f32_16x16x32_bf16 v[132:135], v[64:67], v[164:167], 0
    v_mfma_f32_16x16x32_bf16 v[140:143], v[72:75], v[164:167], 0
    v_mfma_f32_16x16x32_bf16 v[136:139], v[68:71], v[164:167], 0
    v_mfma_f32_16x16x32_bf16 v[144:147], v[76:79], v[164:167], 0
    v_mfma_f32_16x16x32_bf16 v[132:135], v[72:75], v[172:175], v[132:135]
    v_mfma_f32_16x16x32_bf16 v[140:143], v[64:67], v[168:171], v[140:143]
    v_mfma_f32_16x16x32_bf16 v[136:139], v[76:79], v[172:175], v[136:139]
    v_mfma_f32_16x16x32_bf16 v[144:147], v[68:71], v[168:171], v[144:147]
    v_mov_b32 v108, 0x3acccccd
    v_mul_f32 v106, s49, v108
    v_sub_f32 v96, v96, v106
    v_sub_f32 v97, v97, v106
    v_sub_f32 v98, v98, v106
    v_sub_f32 v99, v99, v106
    v_sub_f32 v100, v100, v106
    v_sub_f32 v101, v101, v106
    v_sub_f32 v102, v102, v106
    v_sub_f32 v103, v103, v106
    v_sub_f32 v104, v104, v106
    v_sub_f32 v105, v105, v106
    v_mul_f32 v110, v96, v96
    v_mul_f32 v109, v97, v97
    v_fmac_f32 v110, v98, v98
    v_fmac_f32 v109, v99, v99
    v_fmac_f32 v110, v100, v100
    v_fmac_f32 v109, v101, v101
    v_fmac_f32 v110, v102, v102
    v_fmac_f32 v109, v103, v103
    v_fmac_f32 v110, v104, v104
    v_fmac_f32 v109, v105, v105
    v_add_f32 v110, v110, v109
    s_nop 1
    v_add_f32_dpp v110, v110, v110 row_shr:1 row_mask:0xf bank_mask:0xf bound_ctrl:0
    s_nop 1
    v_add_f32_dpp v110, v110, v110 row_shr:2 row_mask:0xf bank_mask:0xf bound_ctrl:0
    s_nop 1
    v_add_f32_dpp v110, v110, v110 row_shr:4 row_mask:0xf bank_mask:0xf bound_ctrl:0
    s_nop 1
    v_add_f32_dpp v110, v110, v110 row_shr:8 row_mask:0xf bank_mask:0xf bound_ctrl:0
    s_nop 1
    v_add_f32_dpp v110, v110, v110 row_bcast:15 row_mask:0xa bank_mask:0xf
    s_nop 1
    v_add_f32_dpp v110, v110, v110 row_bcast:31 row_mask:0xc bank_mask:0xf
    v_cmp_eq_u32 vcc, 0, v1
    s_nop 1
    v_cndmask_b32 v140, v140, v136, vcc
    v_cvt_pk_bf16_f32 v148, v132, v140
    v_cvt_pk_bf16_f32 v152, v136, -v144
    v_cvt_pk_bf16_f32 v149, v133, v141
    v_cvt_pk_bf16_f32 v153, v137, -v145
    v_cvt_pk_bf16_f32 v150, v134, v142
    v_cvt_pk_bf16_f32 v154, v138, -v146
    v_cvt_pk_bf16_f32 v151, v135, v143
    v_cvt_pk_bf16_f32 v155, v139, -v147
    ds_write_b32 v84, v148 offset:0
    ds_write_b32 v85, v152 offset:240
    ds_write_b32 v84, v149 offset:80
    ds_write_b32 v85, v153 offset:160
    ds_write_b32 v84, v150 offset:160
    ds_write_b32 v85, v154 offset:80
    ds_write_b32 v84, v151 offset:240
    ds_write_b32 v85, v155 offset:0
    v_readlane_b32 s49, v110, 63
    s_nop 1
    v_mul_f32 v110, s49, v108
    v_cvt_pk_bf16_f32 v110, v110, v110
    v_lshlrev_b32 v110, 16, v110
    v_add_f32 v110, 0x3727c5ac, v110
    v_cvt_pk_bf16_f32 v110, v110, v110
    v_lshlrev_b32 v110, 16, v110
    v_sqrt_f32 v110, v110
    s_nop 0
    v_cvt_pk_bf16_f32 v110, v110, v110
    v_lshlrev_b32 v110, 16, v110
    v_rcp_f32 v110, v110
    v_mov_b32 v108, s50
    v_cvt_pk_bf16_f32 v108, v108, v108
    v_lshlrev_b32 v108, 16, v108
    v_mul_f32 v108, 0xbfb8aa3b, v108
    v_mul_f32 v96, v96, v110
    v_mul_f32 v97, v97, v110
    v_cvt_pk_bf16_f32 v111, v96, v97
    ds_write_b32 v80, v111 offset:10752
    v_mul_f32 v98, v98, v110
    v_mul_f32 v99, v99, v110
    v_cvt_pk_bf16_f32 v111, v98, v99
    ds_write_b32 v80, v111 offset:11008
    v_mul_f32 v100, v100, v110
    v_mul_f32 v101, v101, v110
    v_cvt_pk_bf16_f32 v111, v100, v101
    ds_write_b32 v80, v111 offset:11264
    v_mul_f32 v102, v102, v110
    v_mul_f32 v103, v103, v110
    v_cvt_pk_bf16_f32 v111, v102, v103
    ds_write_b32 v80, v111 offset:11520
    v_mul_f32 v104, v104, v110
    v_mul_f32 v105, v105, v110
    v_cvt_pk_bf16_f32 v111, v104, v105
    ds_write_b32 v80, v111 offset:11776
    v_exp_f32 v108, v108
    s_nop 0
    v_add_f32 v108, 1.0, v108
    v_rcp_f32 v108, v108
    s_nop 0
    v_cvt_pk_bf16_f32 v176, v108, v108
    v_lshlrev_b32 v176, 16, v176
    v_sub_f32 v108, 1.0, v176
    v_cvt_pk_bf16_f32 v177, v108, v108
    v_lshlrev_b32 v177, 16, v177
    s_cmp_eq_u32 s32, 0
    s_cbranch_scc1 K_rw_sp
    s_waitcnt vmcnt(3)
K_rw_sp:
    s_waitcnt vmcnt(7)
    v_lshlrev_b32 v31, 16, v31
    v_lshlrev_b32 v32, 16, v32
    s_nop 0
    v_mov_b32_dpp v184, v31 quad_perm:[0,0,0,0] row_mask:0xf bank_mask:0xf
    v_mov_b32_dpp v188, v32 quad_perm:[0,0,0,0] row_mask:0xf bank_mask:0xf
    v_mov_b32_dpp v185, v31 quad_perm:[1,1,1,1] row_mask:0xf bank_mask:0xf
    v_mov_b32_dpp v189, v32 quad_perm:[1,1,1,1] row_mask:0xf bank_mask:0xf
    v_mov_b32_dpp v186, v31 quad_perm:[2,2,2,2] row_mask:0xf bank_mask:0xf
    v_mov_b32_dpp v190, v32 quad_perm:[2,2,2,2] row_mask:0xf bank_mask:0xf
    v_mov_b32_dpp v187, v31 quad_perm:[3,3,3,3] row_mask:0xf bank_mask:0xf
    v_mov_b32_dpp v191, v32 quad_perm:[3,3,3,3] row_mask:0xf bank_mask:0xf
    v_add_f32 v184, v184, v185
    v_sub_f32 v188, v188, v189
    v_add_f32 v186, v186, v187
    v_sub_f32 v190, v190, v191
    v_add_f32 v180, v184, v186
    v_add_f32 v181, v188, v190
    v_sub_f32 v182, v184, v186
    v_sub_f32 v183, v188, v190
    v_mul_f32 v180, 0x3e000000, v180
    v_mul_f32 v181, 0x3e000000, v181
    v_mul_f32 v182, 0x3e000000, v182
    v_mul_f32 v183, 0x3e000000, v183
    s_lshl_b32 s51, s97, 3
    s_add_u32 s51, s51, 7897088
    s_lshl_b32 s52, s97, 4
    s_add_u32 s52, s52, 7864320
    s_waitcnt lgkmcnt(0)
    s_barrier
    ds_read_b64_tr_b16 v[192:193], v83
    ds_read_b64_tr_b16 v[194:195], v83 offset:5376
    ds_read2_b64 v[200:203], v87 offset0:0 offset1:162
    v_mov_b32 v108, 0
    s_cmp_lt_u32 s3, 2
    s_cbranch_scc0 K_p1skip2
    ds_read_b64_tr_b16 v[196:197], v83 offset:1024
    ds_read_b64_tr_b16 v[198:199], v83 offset:6400
    v_add_u32 v109, 1024, v87
    ds_read2_b64 v[204:207], v109 offset0:0 offset1:162
    s_add_u32 s57, s54, 32768
    s_add_u32 s58, s55, 2097152
    s_waitcnt lgkmcnt(0)
    buffer_store_dwordx4 v[196:199], v86, s[16:19], s57 offen sc1
    buffer_store_dwordx4 v[204:207], v88, s[16:19], s58 offen sc1
K_p1skip2:
    s_waitcnt lgkmcnt(0)
    buffer_store_dwordx4 v[192:195], v86, s[16:19], s54 offen sc1
    buffer_store_dwordx4 v[200:203], v88, s[16:19], s55 offen sc1
    s_mov_b64 s[22:23], exec
    s_mov_b64 exec, 1
    buffer_store_dwordx2 v[176:177], v108, s[16:19], s51 offen sc1
    buffer_store_dwordx4 v[180:183], v108, s[16:19], s52 offen sc1
    s_mov_b64 exec, s[22:23]
    s_cmp_lt_u32 s3, 4
    s_cbranch_scc0 K_p1nofi
    s_mul_i32 s49, s2, 200
    v_add_u32 v208, s49, v0
    v_lshrrev_b32 v216, 6, v208
    v_mul_u32_u24 v217, 205, v216
    v_lshrrev_b32 v217, 13, v217
    v_mul_u32_u24 v218, 40, v217
    v_sub_u32 v218, v216, v218
    v_and_b32 v219, 15, v208
    v_lshl_add_u32 v219, v218, 4, v219
    v_bfe_u32 v220, v208, 4, 2
    v_lshlrev_b32 v220, 2, v220
    v_lshl_add_u32 v220, v217, 4, v220
    v_cvt_f32_u32 v224, v219
    v_mul_f32 v224, 0x3acccccd, v224
    v_add_u32 v221, 0, v220
    v_cvt_f32_u32 v221, v221
    v_mul_f32 v221, v221, v224
    v_fract_f32 v221, v221
    v_cos_f32 v222, v221
    v_sin_f32 v223, v221
    s_nop 0
    v_xor_b32 v223, 0x80000000, v223
    v_and_b32 v221, 1, v219
    v_lshlrev_b32 v221, 31, v221
    v_or_b32 v221, 1.0, v221
    v_cmp_eq_u32 vcc, 0, v220
    s_nop 1
    v_cndmask_b32 v223, v223, v221, vcc
    v_cvt_pk_bf16_f32 v212, v222, v223
    v_add_u32 v221, 1, v220
    v_cvt_f32_u32 v221, v221
    v_mul_f32 v221, v221, v224
    v_fract_f32 v221, v221
    v_cos_f32 v222, v221
    v_sin_f32 v223, v221
    s_nop 0
    v_xor_b32 v223, 0x80000000, v223
    v_cvt_pk_bf16_f32 v213, v222, v223
    v_add_u32 v221, 2, v220
    v_cvt_f32_u32 v221, v221
    v_mul_f32 v221, v221, v224
    v_fract_f32 v221, v221
    v_cos_f32 v222, v221
    v_sin_f32 v223, v221
    s_nop 0
    v_xor_b32 v223, 0x80000000, v223
    v_cvt_pk_bf16_f32 v214, v222, v223
    v_add_u32 v221, 3, v220
    v_cvt_f32_u32 v221, v221
    v_mul_f32 v221, v221, v224
    v_fract_f32 v221, v221
    v_cos_f32 v222, v221
    v_sin_f32 v223, v221
    s_nop 0
    v_xor_b32 v223, 0x80000000, v223
    v_cvt_pk_bf16_f32 v215, v222, v223
    v_lshlrev_b32 v208, 4, v208
    v_cmp_gt_u32 vcc, 200, v0
    s_nop 0
    s_and_saveexec_b64 s[22:23], vcc
    s_mov_b32 s53, 7913472
    buffer_store_dwordx4 v[212:215], v208, s[16:19], s53 offen sc1
    s_mov_b64 exec, s[22:23]
K_p1nofi:
    s_cmp_ge_u32 s3, 4
    s_cbranch_scc0 K_noprio
    s_setprio 1
K_noprio:
    s_cmp_eq_u32 s32, 0
    s_cbranch_scc0 K_fft
    s_waitcnt vmcnt(0)
    s_mov_b32 s60, 0
Kg_nonce:
    v_readfirstlane_b32 s20, v6
    v_readfirstlane_b32 s21, v7
    s_nop 0
    s_cmp_lg_u32 s21, 0
    s_cbranch_scc1 Kg_nonceok
    s_add_u32 s60, s60, 1
    s_cmp_lt_u32 s60, 262144
    s_cbranch_scc0 Kg_nonceok
    v_mov_b32 v232, 0
    global_load_dwordx2 v[6:7], v232, s[84:85] sc1
    s_waitcnt vmcnt(0)
    s_branch Kg_nonce
Kg_nonceok:
    s_mul_i32 s58, s2, 32
    s_add_u32 s58, s58, 13565952
    v_mov_b32 v232, s20
    v_mov_b32 v233, s21
    v_mov_b32 v234, 0
    s_barrier
    s_cmp_eq_u32 s3, s88
    s_cbranch_scc0 K_g1nf0
    s_mov_b64 exec, 1
    buffer_store_dwordx2 v[232:233], v234, s[16:19], s58 offen sc1
    s_mov_b64 exec, -1
K_g1nf0:
    s_barrier
    s_add_u32 m0, s38, 0
    s_mov_b32 s62, s40
    buffer_load_dwordx4 v8, s[4:7], s62 offen lds
    s_add_u32 m0, s38, 1024
    s_add_u32 s62, s62, 27648
    buffer_load_dwordx4 v9, s[4:7], s62 offen lds
    s_add_u32 m0, s38, 2048
    s_add_u32 s62, s62, 27648
    buffer_load_dwordx4 v8, s[4:7], s62 offen lds
    s_add_u32 m0, s38, 3072
    s_add_u32 s62, s62, 27648
    buffer_load_dwordx4 v9, s[4:7], s62 offen lds
    s_add_u32 m0, s38, 4096
    s_mov_b32 s62, s41
    buffer_load_dwordx4 v8, s[4:7], s62 offen lds
    s_add_u32 m0, s38, 5120
    s_add_u32 s62, s62, 27648
    buffer_load_dwordx4 v9, s[4:7], s62 offen lds
    s_add_u32 m0, s38, 6144
    s_add_u32 s62, s62, 27648
    buffer_load_dwordx4 v8, s[4:7], s62 offen lds
    s_add_u32 m0, s38, 7168
    s_add_u32 s62, s62, 27648
    buffer_load_dwordx4 v9, s[4:7], s62 offen lds
    s_add_u32 m0, s38, 8192
    s_mov_b32 s62, s42
    buffer_load_dwordx4 v8, s[4:7], s62 offen lds
    s_add_u32 m0, s38, 9216
    s_add_u32 s62, s62, 27648
    buffer_load_dwordx4 v9, s[4:7], s62 offen lds
    s_add_u32 m0, s38, 10240
    s_add_u32 s62, s62, 27648
    buffer_load_dwordx4 v8, s[4:7], s62 offen lds
    s_add_u32 m0, s38, 11264
    s_add_u32 s62, s62, 27648
    buffer_load_dwordx4 v9, s[4:7], s62 offen lds
    s_add_u32 m0, s39, 0
    s_mov_b32 s62, s43
    buffer_load_dwordx4 v8, s[4:7], s62 offen lds
    s_add_u32 m0, s39, 1024
    s_add_u32 s62, s62, 27648
    buffer_load_dwordx4 v9, s[4:7], s62 offen lds
    s_add_u32 m0, s39, 2048
    s_add_u32 s62, s62, 27648
    buffer_load_dwordx4 v8, s[4:7], s62 offen lds
    s_add_u32 m0, s39, 3072
    s_add_u32 s62, s62, 27648
    buffer_load_dwordx4 v9, s[4:7], s62 offen lds
    s_add_u32 m0, s39, 32768
    s_mov_b32 s62, s44
    buffer_load_dwordx4 v8, s[4:7], s62 offen lds
    s_add_u32 m0, s39, 33792
    s_add_u32 s62, s62, 27648
    buffer_load_dwordx4 v9, s[4:7], s62 offen lds
    s_add_u32 m0, s39, 34816
    s_add_u32 s62, s62, 27648
    buffer_load_dwordx4 v8, s[4:7], s62 offen lds
    s_add_u32 m0, s39, 35840
    s_add_u32 s62, s62, 27648
    buffer_load_dwordx4 v9, s[4:7], s62 offen lds
    v_lshrrev_b32 v236, 2, v2
    v_and_b32 v237, 3, v2
    v_lshl_add_u32 v238, v3, 3, v236
    v_and_b32 v239, 2, v236
    v_and_b32 v240, 1, v3
    v_lshl_add_u32 v239, v240, 2, v239
    v_lshrrev_b32 v240, 1, v237
    v_xor_b32 v240, v240, v239
    v_lshlrev_b32 v240, 4, v240
    v_lshl_add_u32 v240, v238, 7, v240
    v_and_b32 v237, 1, v237
    v_lshl_add_u32 v240, v237, 3, v240
    v_add_u32 v10, s38, v240
    v_xor_b32 v11, 32, v10
    v_xor_b32 v12, 64, v10
    v_xor_b32 v13, 96, v10
    s_lshl_b32 s58, s3, 13
    s_sub_u32 s58, 98304, s58
    v_add_u32 v232, s58, v10
    v_add_u32 v233, s58, v11
    v_add_u32 v234, s58, v12
    v_add_u32 v235, s58, v13
    s_mov_b32 s12, s74
    s_and_b32 s13, s75, 0xffff
    s_mov_b32 s14, 0xd80
    s_mov_b32 s15, 0x20000
    v_lshrrev_b32 v236, 8, v0
    v_lshlrev_b32 v236, 5, v236
    v_bfe_u32 v237, v0, 1, 1
    v_lshl_add_u32 v236, v237, 4, v236
    v_bfe_u32 v237, v0, 6, 2
    v_lshl_add_u32 v236, v237, 2, v236
    v_and_b32 v237, 1, v0
    v_lshl_add_u32 v236, v237, 1, v236
    v_lshlrev_b32 v236, 1, v236
    s_lshl_b32 s58, s34, 7
    buffer_load_dword v16, v236, s[12:15], s58 offen
    v_lshrrev_b32 v236, 8, v0
    v_bfe_u32 v237, v0, 1, 1
    v_lshl_add_u32 v236, v236, 1, v237
    v_lshlrev_b32 v236, 10, v236
    v_bfe_u32 v237, v0, 2, 6
    v_lshl_add_u32 v236, v237, 4, v236
    v_and_b32 v237, 1, v0
    v_lshl_add_u32 v19, v237, 3, v236
    v_add_u32 v19, 98304, v19
    v_lshlrev_b32 v15, 2, v0
    v_add_u32 v15, 90112, v15
    v_lshlrev_b32 v14, 4, v1
    v_add_u32 v18, s39, v14
    v_mov_b32 v20, 0xc0135761
    v_mov_b32 v21, 0xbdd2d3e8
    s_add_u32 s64, s33, 0
    s_cmp_ge_u32 s64, 8
    s_cselect_b32 s61, 8, 0
    s_sub_u32 s64, s64, s61
    s_mul_i32 s64, s64, 40960
    s_add_u32 s65, s33, 1
    s_cmp_ge_u32 s65, 8
    s_cselect_b32 s61, 8, 0
    s_sub_u32 s65, s65, s61
    s_mul_i32 s65, s65, 40960
    s_add_u32 s66, s33, 2
    s_cmp_ge_u32 s66, 8
    s_cselect_b32 s61, 8, 0
    s_sub_u32 s66, s66, s61
    s_mul_i32 s66, s66, 40960
    s_add_u32 s67, s33, 3
    s_cmp_ge_u32 s67, 8
    s_cselect_b32 s61, 8, 0
    s_sub_u32 s67, s67, s61
    s_mul_i32 s67, s67, 40960
    s_add_u32 s68, s33, 4
    s_cmp_ge_u32 s68, 8
    s_cselect_b32 s61, 8, 0
    s_sub_u32 s68, s68, s61
    s_mul_i32 s68, s68, 40960
    s_add_u32 s69, s33, 5
    s_cmp_ge_u32 s69, 8
    s_cselect_b32 s61, 8, 0
    s_sub_u32 s69, s69, s61
    s_mul_i32 s69, s69, 40960
    s_add_u32 s70, s33, 6
    s_cmp_ge_u32 s70, 8
    s_cselect_b32 s61, 8, 0
    s_sub_u32 s70, s70, s61
    s_mul_i32 s70, s70, 40960
    s_add_u32 s71, s33, 7
    s_cmp_ge_u32 s71, 8
    s_cselect_b32 s61, 8, 0
    s_sub_u32 s71, s71, s61
    s_mul_i32 s71, s71, 40960
    s_mul_i32 s59, s3, 327680
    s_mul_i32 s58, s33, 5120
    s_add_u32 s59, s59, s58
    s_add_u32 s59, s59, 0
    s_mov_b32 s63, 0
    s_add_u32 s49, s63, 0
    s_cmp_ge_u32 s49, 5
    s_cselect_b32 s61, 5, 0
    s_sub_u32 s49, s49, s61
    s_mul_i32 s49, s49, 1024
    s_add_u32 s49, s49, s59
    s_add_u32 s50, s63, 1
    s_cmp_ge_u32 s50, 5
    s_cselect_b32 s61, 5, 0
    s_sub_u32 s50, s50, s61
    s_mul_i32 s50, s50, 1024
    s_add_u32 s50, s50, s59
    s_add_u32 s51, s63, 2
    s_cmp_ge_u32 s51, 5
    s_cselect_b32 s61, 5, 0
    s_sub_u32 s51, s51, s61
    s_mul_i32 s51, s51, 1024
    s_add_u32 s51, s51, s59
    s_add_u32 s52, s63, 3
    s_cmp_ge_u32 s52, 5
    s_cselect_b32 s61, 5, 0
    s_sub_u32 s52, s52, s61
    s_mul_i32 s52, s52, 1024
    s_add_u32 s52, s52, s59
    s_add_u32 s53, s63, 4
    s_cmp_ge_u32 s53, 5
    s_cselect_b32 s61, 5, 0
    s_sub_u32 s53, s53, s61
    s_mul_i32 s53, s53, 1024
    s_add_u32 s53, s53, s59
    s_mul_i32 s59, s34, 81920
    s_add_u32 s59, s59, s58
    s_add_u32 s59, s59, 8732672
    s_add_u32 s96, s63, 0
    s_cmp_ge_u32 s96, 5
    s_cselect_b32 s61, 5, 0
    s_sub_u32 s96, s96, s61
    s_mul_i32 s96, s96, 1024
    s_add_u32 s96, s96, s59
    s_add_u32 s97, s63, 1
    s_cmp_ge_u32 s97, 5
    s_cselect_b32 s61, 5, 0
    s_sub_u32 s97, s97, s61
    s_mul_i32 s97, s97, 1024
    s_add_u32 s97, s97, s59
    s_add_u32 s98, s63, 2
    s_cmp_ge_u32 s98, 5
    s_cselect_b32 s61, 5, 0
    s_sub_u32 s98, s98, s61
    s_mul_i32 s98, s98, 1024
    s_add_u32 s98, s98, s59
    s_add_u32 s99, s63, 3
    s_cmp_ge_u32 s99, 5
    s_cselect_b32 s61, 5, 0
    s_sub_u32 s99, s99, s61
    s_mul_i32 s99, s99, 1024
    s_add_u32 s99, s99, s59
    s_add_u32 s100, s63, 4
    s_cmp_ge_u32 s100, 5
    s_cselect_b32 s61, 5, 0
    s_sub_u32 s100, s100, s61
    s_mul_i32 s100, s100, 1024
    s_add_u32 s100, s100, s59
    s_waitcnt vmcnt(16)
    ds_read_b64_tr_b16 v[24:25], v10 offset:0
    ds_read_b64_tr_b16 v[26:27], v10 offset:512
    ds_read_b64_tr_b16 v[28:29], v11 offset:0
    ds_read_b64_tr_b16 v[30:31], v11 offset:512
    ds_read_b64_tr_b16 v[32:33], v12 offset:0
    ds_read_b64_tr_b16 v[34:35], v12 offset:512
    ds_read_b64_tr_b16 v[36:37], v13 offset:0
    ds_read_b64_tr_b16 v[38:39], v13 offset:512
    s_waitcnt lgkmcnt(0)
    s_add_u32 m0, s38, 0
    s_mov_b32 s62, s45
    buffer_load_dwordx4 v8, s[4:7], s62 offen lds
    s_add_u32 m0, s38, 1024
    s_add_u32 s62, s62, 27648
    buffer_load_dwordx4 v9, s[4:7], s62 offen lds
    s_add_u32 m0, s38, 2048
    s_add_u32 s62, s62, 27648
    buffer_load_dwordx4 v8, s[4:7], s62 offen lds
    s_add_u32 m0, s38, 3072
    s_add_u32 s62, s62, 27648
    buffer_load_dwordx4 v9, s[4:7], s62 offen lds
    s_waitcnt vmcnt(16)
    ds_read_b64_tr_b16 v[40:41], v10 offset:4096
    ds_read_b64_tr_b16 v[42:43], v10 offset:4608
    ds_read_b64_tr_b16 v[44:45], v11 offset:4096
    ds_read_b64_tr_b16 v[46:47], v11 offset:4608
    ds_read_b64_tr_b16 v[48:49], v12 offset:4096
    ds_read_b64_tr_b16 v[50:51], v12 offset:4608
    ds_read_b64_tr_b16 v[52:53], v13 offset:4096
    ds_read_b64_tr_b16 v[54:55], v13 offset:4608
    s_waitcnt lgkmcnt(0)
    s_add_u32 m0, s38, 4096
    s_mov_b32 s62, s46
    buffer_load_dwordx4 v8, s[4:7], s62 offen lds
    s_add_u32 m0, s38, 5120
    s_add_u32 s62, s62, 27648
    buffer_load_dwordx4 v9, s[4:7], s62 offen lds
    s_add_u32 m0, s38, 6144
    s_add_u32 s62, s62, 27648
    buffer_load_dwordx4 v8, s[4:7], s62 offen lds
    s_add_u32 m0, s38, 7168
    s_add_u32 s62, s62, 27648
    buffer_load_dwordx4 v9, s[4:7], s62 offen lds
    s_waitcnt vmcnt(16)
    ds_read_b64_tr_b16 v[56:57], v10 offset:8192
    ds_read_b64_tr_b16 v[58:59], v10 offset:8704
    ds_read_b64_tr_b16 v[60:61], v11 offset:8192
    ds_read_b64_tr_b16 v[62:63], v11 offset:8704
    ds_read_b64_tr_b16 v[64:65], v12 offset:8192
    ds_read_b64_tr_b16 v[66:67], v12 offset:8704
    ds_read_b64_tr_b16 v[68:69], v13 offset:8192
    ds_read_b64_tr_b16 v[70:71], v13 offset:8704
    s_waitcnt lgkmcnt(0)
    s_add_u32 m0, s38, 8192
    s_mov_b32 s62, s47
    buffer_load_dwordx4 v8, s[4:7], s62 offen lds
    s_add_u32 m0, s38, 9216
    s_add_u32 s62, s62, 27648
    buffer_load_dwordx4 v9, s[4:7], s62 offen lds
    s_add_u32 m0, s38, 10240
    s_add_u32 s62, s62, 27648
    buffer_load_dwordx4 v8, s[4:7], s62 offen lds
    s_add_u32 m0, s38, 11264
    s_add_u32 s62, s62, 27648
    buffer_load_dwordx4 v9, s[4:7], s62 offen lds
    s_waitcnt vmcnt(16)
    ds_read_b64_tr_b16 v[72:73], v232 offset:0
    ds_read_b64_tr_b16 v[74:75], v232 offset:512
    ds_read_b64_tr_b16 v[76:77], v233 offset:0
    ds_read_b64_tr_b16 v[78:79], v233 offset:512
    ds_read_b64_tr_b16 v[80:81], v234 offset:0
    ds_read_b64_tr_b16 v[82:83], v234 offset:512
    ds_read_b64_tr_b16 v[84:85], v235 offset:0
    ds_read_b64_tr_b16 v[86:87], v235 offset:512
    s_waitcnt vmcnt(12)
    ds_read_b64_tr_b16 v[88:89], v232 offset:32768
    ds_read_b64_tr_b16 v[90:91], v232 offset:33280
    ds_read_b64_tr_b16 v[92:93], v233 offset:32768
    ds_read_b64_tr_b16 v[94:95], v233 offset:33280
    ds_read_b64_tr_b16 v[96:97], v234 offset:32768
    ds_read_b64_tr_b16 v[98:99], v234 offset:33280
    ds_read_b64_tr_b16 v[100:101], v235 offset:32768
    ds_read_b64_tr_b16 v[102:103], v235 offset:33280
    s_waitcnt vmcnt(8)
    ds_read_b64_tr_b16 v[104:105], v10 offset:0
    ds_read_b64_tr_b16 v[106:107], v10 offset:512
    ds_read_b64_tr_b16 v[108:109], v11 offset:0
    ds_read_b64_tr_b16 v[110:111], v11 offset:512
    ds_read_b64_tr_b16 v[112:113], v12 offset:0
    ds_read_b64_tr_b16 v[114:115], v12 offset:512
    ds_read_b64_tr_b16 v[116:117], v13 offset:0
    ds_read_b64_tr_b16 v[118:119], v13 offset:512
    s_waitcnt vmcnt(4)
    ds_read_b64_tr_b16 v[120:121], v10 offset:4096
    ds_read_b64_tr_b16 v[122:123], v10 offset:4608
    ds_read_b64_tr_b16 v[124:125], v11 offset:4096
    ds_read_b64_tr_b16 v[126:127], v11 offset:4608
    ds_read_b64_tr_b16 v[128:129], v12 offset:4096
    ds_read_b64_tr_b16 v[130:131], v12 offset:4608
    ds_read_b64_tr_b16 v[132:133], v13 offset:4096
    ds_read_b64_tr_b16 v[134:135], v13 offset:4608
    s_waitcnt vmcnt(0)
    ds_read_b64_tr_b16 v[136:137], v10 offset:8192
    ds_read_b64_tr_b16 v[138:139], v10 offset:8704
    ds_read_b64_tr_b16 v[140:141], v11 offset:8192
    ds_read_b64_tr_b16 v[142:143], v11 offset:8704
    ds_read_b64_tr_b16 v[144:145], v12 offset:8192
    ds_read_b64_tr_b16 v[146:147], v12 offset:8704
    ds_read_b64_tr_b16 v[148:149], v13 offset:8192
    ds_read_b64_tr_b16 v[150:151], v13 offset:8704
    s_waitcnt lgkmcnt(0)
    s_mul_i32 s58, s3, 1024
    s_add_u32 s58, s58, 13565952
    v_mul_u32_u24 v184, 32, v1
    s_mov_b32 s60, 0
    v_cmp_gt_u32 vcc, 32, v1
    s_nop 0
    s_and_saveexec_b64 s[22:23], vcc
K_poll_g1:
    buffer_load_dwordx2 v[186:187], v184, s[16:19], s58 offen sc1
    s_waitcnt vmcnt(0)
    v_cmp_eq_u64 s[54:55], v[186:187], s[20:21]
    s_nop 0
    s_mov_b64 s[56:57], s[54:55]
    s_cmp_eq_u64 s[56:57], exec
    s_cbranch_scc1 K_pollok_g1
    s_add_u32 s60, s60, 1
    s_cmp_lt_u32 s60, 262144
    s_cbranch_scc0 K_pollok_g1
    s_sleep 1
    s_branch K_poll_g1
K_pollok_g1:
    s_mov_b64 exec, s[22:23]
    v_and_b32 v17, 0xffff0000, v16
    v_lshlrev_b32 v16, 16, v16
    s_sub_u32 s58, s3, 6
    s_and_b32 s58, s58, 1
    s_lshl_b32 s59, s58, 10
    s_add_u32 s59, s59, 90112
    v_add_u32 v8, s59, v14
    s_mul_i32 s59, s58, 40960
    v_add_u32 v9, s59, v14
    s_add_u32 s58, s49, s64
    buffer_load_dwordx4 v[184:187], v14, s[16:19], s58 offen sc1
    s_add_u32 s58, s49, s65
    buffer_load_dwordx4 v[188:191], v14, s[16:19], s58 offen sc1
    s_add_u32 s58, s49, s66
    buffer_load_dwordx4 v[192:195], v14, s[16:19], s58 offen sc1
    s_add_u32 s58, s49, s67
    buffer_load_dwordx4 v[196:199], v14, s[16:19], s58 offen sc1
    s_add_u32 s58, s49, s68
    buffer_load_dwordx4 v[200:203], v14, s[16:19], s58 offen sc1
    s_add_u32 s58, s49, s69
    buffer_load_dwordx4 v[204:207], v14, s[16:19], s58 offen sc1
    s_add_u32 s58, s49, s70
    buffer_load_dwordx4 v[208:211], v14, s[16:19], s58 offen sc1
    s_add_u32 s58, s49, s71
    buffer_load_dwordx4 v[212:215], v14, s[16:19], s58 offen sc1
    s_add_u32 s58, s50, s64
    buffer_load_dwordx4 v[216:219], v14, s[16:19], s58 offen sc1
    s_add_u32 s58, s50, s65
    buffer_load_dwordx4 v[220:223], v14, s[16:19], s58 offen sc1
    s_add_u32 s58, s50, s66
    buffer_load_dwordx4 v[224:227], v14, s[16:19], s58 offen sc1
    s_add_u32 s58, s50, s67
    buffer_load_dwordx4 v[228:231], v14, s[16:19], s58 offen sc1
    s_waitcnt vmcnt(11)
    v_mfma_f32_16x16x32_bf16 v[152:155], v[24:27], v[184:187], 0
    v_mfma_f32_16x16x32_bf16 v[156:159], v[28:31], v[184:187], 0
    v_mfma_f32_16x16x32_bf16 v[160:163], v[32:35], v[184:187], 0
    v_mfma_f32_16x16x32_bf16 v[164:167], v[36:39], v[184:187], 0
    s_add_u32 s58, s50, s68
    buffer_load_dwordx4 v[184:187], v14, s[16:19], s58 offen sc1
    s_waitcnt vmcnt(11)
    v_mfma_f32_16x16x32_bf16 v[152:155], v[40:43], v[188:191], v[152:155]
    v_mfma_f32_16x16x32_bf16 v[156:159], v[44:47], v[188:191], v[156:159]
    v_mfma_f32_16x16x32_bf16 v[160:163], v[48:51], v[188:191], v[160:163]
    v_mfma_f32_16x16x32_bf16 v[164:167], v[52:55], v[188:191], v[164:167]
    s_add_u32 s58, s50, s69
    buffer_load_dwordx4 v[188:191], v14, s[16:19], s58 offen sc1
    s_waitcnt vmcnt(11)
    v_mfma_f32_16x16x32_bf16 v[152:155], v[56:59], v[192:195], v[152:155]
    v_mfma_f32_16x16x32_bf16 v[156:159], v[60:63], v[192:195], v[156:159]
    v_mfma_f32_16x16x32_bf16 v[160:163], v[64:67], v[192:195], v[160:163]
    v_mfma_f32_16x16x32_bf16 v[164:167], v[68:71], v[192:195], v[164:167]
    s_add_u32 s58, s50, s70
    buffer_load_dwordx4 v[192:195], v14, s[16:19], s58 offen sc1
    s_waitcnt vmcnt(11)
    v_mfma_f32_16x16x32_bf16 v[152:155], v[72:75], v[196:199], v[152:155]
    v_mfma_f32_16x16x32_bf16 v[156:159], v[76:79], v[196:199], v[156:159]
    v_mfma_f32_16x16x32_bf16 v[160:163], v[80:83], v[196:199], v[160:163]
    v_mfma_f32_16x16x32_bf16 v[164:167], v[84:87], v[196:199], v[164:167]
    s_add_u32 s58, s50, s71
    buffer_load_dwordx4 v[196:199], v14, s[16:19], s58 offen sc1
    s_waitcnt vmcnt(11)
    v_mfma_f32_16x16x32_bf16 v[152:155], v[88:91], v[200:203], v[152:155]
    v_mfma_f32_16x16x32_bf16 v[156:159], v[92:95], v[200:203], v[156:159]
    v_mfma_f32_16x16x32_bf16 v[160:163], v[96:99], v[200:203], v[160:163]
    v_mfma_f32_16x16x32_bf16 v[164:167], v[100:103], v[200:203], v[164:167]
    s_add_u32 s58, s51, s64
    buffer_load_dwordx4 v[200:203], v14, s[16:19], s58 offen sc1
    s_waitcnt vmcnt(11)
    v_mfma_f32_16x16x32_bf16 v[152:155], v[104:107], v[204:207], v[152:155]
    v_mfma_f32_16x16x32_bf16 v[156:159], v[108:111], v[204:207], v[156:159]
    v_mfma_f32_16x16x32_bf16 v[160:163], v[112:115], v[204:207], v[160:163]
    v_mfma_f32_16x16x32_bf16 v[164:167], v[116:119], v[204:207], v[164:167]
    s_add_u32 s58, s51, s65
    buffer_load_dwordx4 v[204:207], v14, s[16:19], s58 offen sc1
    s_waitcnt vmcnt(11)
    v_mfma_f32_16x16x32_bf16 v[152:155], v[120:123], v[208:211], v[152:155]
    v_mfma_f32_16x16x32_bf16 v[156:159], v[124:127], v[208:211], v[156:159]
    v_mfma_f32_16x16x32_bf16 v[160:163], v[128:131], v[208:211], v[160:163]
    v_mfma_f32_16x16x32_bf16 v[164:167], v[132:135], v[208:211], v[164:167]
    s_add_u32 s58, s51, s66
    buffer_load_dwordx4 v[208:211], v14, s[16:19], s58 offen sc1
    s_waitcnt vmcnt(11)
    v_mfma_f32_16x16x32_bf16 v[152:155], v[136:139], v[212:215], v[152:155]
    v_mfma_f32_16x16x32_bf16 v[156:159], v[140:143], v[212:215], v[156:159]
    v_mfma_f32_16x16x32_bf16 v[160:163], v[144:147], v[212:215], v[160:163]
    v_mfma_f32_16x16x32_bf16 v[164:167], v[148:151], v[212:215], v[164:167]
    s_add_u32 s58, s51, s67
    buffer_load_dwordx4 v[212:215], v14, s[16:19], s58 offen sc1
    s_waitcnt vmcnt(11)
    v_mfma_f32_16x16x32_bf16 v[168:171], v[24:27], v[216:219], 0
    v_mfma_f32_16x16x32_bf16 v[172:175], v[28:31], v[216:219], 0
    v_mfma_f32_16x16x32_bf16 v[176:179], v[32:35], v[216:219], 0
    v_mfma_f32_16x16x32_bf16 v[180:183], v[36:39], v[216:219], 0
    s_add_u32 s58, s51, s68
    buffer_load_dwordx4 v[216:219], v14, s[16:19], s58 offen sc1
    s_waitcnt vmcnt(11)
    v_mfma_f32_16x16x32_bf16 v[168:171], v[40:43], v[220:223], v[168:171]
    v_mfma_f32_16x16x32_bf16 v[172:175], v[44:47], v[220:223], v[172:175]
    v_mfma_f32_16x16x32_bf16 v[176:179], v[48:51], v[220:223], v[176:179]
    v_mfma_f32_16x16x32_bf16 v[180:183], v[52:55], v[220:223], v[180:183]
    s_add_u32 s58, s51, s69
    buffer_load_dwordx4 v[220:223], v14, s[16:19], s58 offen sc1
    s_waitcnt vmcnt(11)
    v_mfma_f32_16x16x32_bf16 v[168:171], v[56:59], v[224:227], v[168:171]
    ds_write_b128 v18, v[152:155] offset:0
    ds_write_b128 v18, v[156:159] offset:1024
    v_mfma_f32_16x16x32_bf16 v[172:175], v[60:63], v[224:227], v[172:175]
    ds_write_b128 v18, v[160:163] offset:2048
    ds_write_b128 v18, v[164:167] offset:3072
    v_mfma_f32_16x16x32_bf16 v[176:179], v[64:67], v[224:227], v[176:179]
    v_mfma_f32_16x16x32_bf16 v[180:183], v[68:71], v[224:227], v[180:183]
    s_add_u32 s58, s51, s70
    buffer_load_dwordx4 v[224:227], v14, s[16:19], s58 offen sc1
    s_waitcnt vmcnt(11)
    v_mfma_f32_16x16x32_bf16 v[168:171], v[72:75], v[228:231], v[168:171]
    s_waitcnt lgkmcnt(0)
    s_barrier
    v_mfma_f32_16x16x32_bf16 v[172:175], v[76:79], v[228:231], v[172:175]
    ds_read2st64_b64 v[232:235], v19 offset0:0 offset1:8
    ds_read2st64_b64 v[236:239], v19 offset0:16 offset1:24
    v_mfma_f32_16x16x32_bf16 v[176:179], v[80:83], v[228:231], v[176:179]
    ds_read2st64_b64 v[240:243], v19 offset0:32 offset1:40
    ds_read2st64_b64 v[244:247], v19 offset0:48 offset1:56
    v_mfma_f32_16x16x32_bf16 v[180:183], v[84:87], v[228:231], v[180:183]
    s_add_u32 s58, s51, s71
    buffer_load_dwordx4 v[228:231], v14, s[16:19], s58 offen sc1
    s_waitcnt vmcnt(11)
    v_mfma_f32_16x16x32_bf16 v[168:171], v[88:91], v[184:187], v[168:171]
    v_mfma_f32_16x16x32_bf16 v[172:175], v[92:95], v[184:187], v[172:175]
    v_mfma_f32_16x16x32_bf16 v[176:179], v[96:99], v[184:187], v[176:179]
    v_mfma_f32_16x16x32_bf16 v[180:183], v[100:103], v[184:187], v[180:183]
    s_add_u32 s58, s52, s64
    buffer_load_dwordx4 v[184:187], v14, s[16:19], s58 offen sc1
    s_waitcnt vmcnt(11)
    v_mfma_f32_16x16x32_bf16 v[168:171], v[104:107], v[188:191], v[168:171]
    s_waitcnt lgkmcnt(0)
    v_add_f32 v232, v232, v234
    v_mfma_f32_16x16x32_bf16 v[172:175], v[108:111], v[188:191], v[172:175]
    v_add_f32 v233, v233, v235
    v_add_f32 v236, v236, v238
    v_mfma_f32_16x16x32_bf16 v[176:179], v[112:115], v[188:191], v[176:179]
    v_add_f32 v237, v237, v239
    v_add_f32 v240, v240, v242
    v_mfma_f32_16x16x32_bf16 v[180:183], v[116:119], v[188:191], v[180:183]
    v_add_f32 v241, v241, v243
    v_add_f32 v244, v244, v246
    s_add_u32 s58, s52, s65
    buffer_load_dwordx4 v[188:191], v14, s[16:19], s58 offen sc1
    s_waitcnt vmcnt(11)
    v_mfma_f32_16x16x32_bf16 v[168:171], v[120:123], v[192:195], v[168:171]
    v_add_f32 v245, v245, v247
    v_add_f32 v232, v232, v236
    v_mfma_f32_16x16x32_bf16 v[172:175], v[124:127], v[192:195], v[172:175]
    v_add_f32 v233, v233, v237
    v_add_f32 v240, v240, v244
    v_mfma_f32_16x16x32_bf16 v[176:179], v[128:131], v[192:195], v[176:179]
    v_add_f32 v241, v241, v245
    v_add_f32 v232, v232, v240
    v_mfma_f32_16x16x32_bf16 v[180:183], v[132:135], v[192:195], v[180:183]
    v_add_f32 v233, v233, v241
    v_add_f32 v248, v232, v16
    s_add_u32 s58, s52, s66
    buffer_load_dwordx4 v[192:195], v14, s[16:19], s58 offen sc1
    s_waitcnt vmcnt(11)
    v_mfma_f32_16x16x32_bf16 v[168:171], v[136:139], v[196:199], v[168:171]
    v_add_f32 v249, v233, v17
    v_mul_f32 v250, v248, v248
    v_mfma_f32_16x16x32_bf16 v[172:175], v[140:143], v[196:199], v[172:175]
    v_mul_f32 v251, v249, v249
    v_fma_f32 v250, v250, v21, v20
    v_mfma_f32_16x16x32_bf16 v[176:179], v[144:147], v[196:199], v[176:179]
    v_fma_f32 v251, v251, v21, v20
    v_mul_f32 v250, v250, v248
    v_mfma_f32_16x16x32_bf16 v[180:183], v[148:151], v[196:199], v[180:183]
    v_mul_f32 v251, v251, v249
    v_exp_f32 v250, v250
    s_add_u32 s58, s52, s67
    buffer_load_dwordx4 v[196:199], v14, s[16:19], s58 offen sc1
    s_waitcnt vmcnt(11)
    v_mfma_f32_16x16x32_bf16 v[152:155], v[24:27], v[200:203], 0
    v_exp_f32 v251, v251
    v_add_f32 v250, 1.0, v250
    v_mfma_f32_16x16x32_bf16 v[156:159], v[28:31], v[200:203], 0
    v_add_f32 v251, 1.0, v251
    v_rcp_f32 v250, v250
    v_mfma_f32_16x16x32_bf16 v[160:163], v[32:35], v[200:203], 0
    v_rcp_f32 v251, v251
    v_mul_f32 v250, v250, v248
    v_mfma_f32_16x16x32_bf16 v[164:167], v[36:39], v[200:203], 0
    v_mul_f32 v251, v251, v249
    v_cvt_pk_bf16_f32 v248, v250, v251
    s_add_u32 s58, s52, s68
    buffer_load_dwordx4 v[200:203], v14, s[16:19], s58 offen sc1
    s_waitcnt vmcnt(11)
    v_mfma_f32_16x16x32_bf16 v[152:155], v[40:43], v[204:207], v[152:155]
    ds_write_b32 v15, v248 offset:0
    v_mfma_f32_16x16x32_bf16 v[156:159], v[44:47], v[204:207], v[156:159]
    v_mfma_f32_16x16x32_bf16 v[160:163], v[48:51], v[204:207], v[160:163]
    v_mfma_f32_16x16x32_bf16 v[164:167], v[52:55], v[204:207], v[164:167]
    s_add_u32 s58, s52, s69
    buffer_load_dwordx4 v[204:207], v14, s[16:19], s58 offen sc1
    s_waitcnt vmcnt(11)
    v_mfma_f32_16x16x32_bf16 v[152:155], v[56:59], v[208:211], v[152:155]
    ds_write_b128 v18, v[168:171] offset:32768
    ds_write_b128 v18, v[172:175] offset:33792
    v_mfma_f32_16x16x32_bf16 v[156:159], v[60:63], v[208:211], v[156:159]
    ds_write_b128 v18, v[176:179] offset:34816
    ds_write_b128 v18, v[180:183] offset:35840
    v_mfma_f32_16x16x32_bf16 v[160:163], v[64:67], v[208:211], v[160:163]
    v_mfma_f32_16x16x32_bf16 v[164:167], v[68:71], v[208:211], v[164:167]
    s_add_u32 s58, s52, s70
    buffer_load_dwordx4 v[208:211], v14, s[16:19], s58 offen sc1
    s_waitcnt vmcnt(11)
    v_mfma_f32_16x16x32_bf16 v[152:155], v[72:75], v[212:215], v[152:155]
    s_waitcnt lgkmcnt(0)
    s_barrier
    v_mfma_f32_16x16x32_bf16 v[156:159], v[76:79], v[212:215], v[156:159]
    ds_read2st64_b64 v[232:235], v19 offset0:64 offset1:72
    ds_read2st64_b64 v[236:239], v19 offset0:80 offset1:88
    v_mfma_f32_16x16x32_bf16 v[160:163], v[80:83], v[212:215], v[160:163]
    ds_read2st64_b64 v[240:243], v19 offset0:96 offset1:104
    ds_read2st64_b64 v[244:247], v19 offset0:112 offset1:120
    v_mfma_f32_16x16x32_bf16 v[164:167], v[84:87], v[212:215], v[164:167]
    s_cmp_ge_u32 s3, 6
    s_cbranch_scc0 K_nous_d1
    ds_read_b128 v[10:13], v8 offset:0
    s_waitcnt lgkmcnt(0)
    buffer_store_dwordx4 v[10:13], v9, s[16:19], s96 offen sc1
K_nous_d1:
    s_add_u32 s58, s52, s71
    buffer_load_dwordx4 v[212:215], v14, s[16:19], s58 offen sc1
    s_waitcnt vmcnt(11)
    v_mfma_f32_16x16x32_bf16 v[152:155], v[88:91], v[216:219], v[152:155]
    v_mfma_f32_16x16x32_bf16 v[156:159], v[92:95], v[216:219], v[156:159]
    v_mfma_f32_16x16x32_bf16 v[160:163], v[96:99], v[216:219], v[160:163]
    v_mfma_f32_16x16x32_bf16 v[164:167], v[100:103], v[216:219], v[164:167]
    s_add_u32 s58, s53, s64
    buffer_load_dwordx4 v[216:219], v14, s[16:19], s58 offen sc1
    s_waitcnt vmcnt(11)
    v_mfma_f32_16x16x32_bf16 v[152:155], v[104:107], v[220:223], v[152:155]
    s_waitcnt lgkmcnt(0)
    v_add_f32 v232, v232, v234
    v_mfma_f32_16x16x32_bf16 v[156:159], v[108:111], v[220:223], v[156:159]
    v_add_f32 v233, v233, v235
    v_add_f32 v236, v236, v238
    v_mfma_f32_16x16x32_bf16 v[160:163], v[112:115], v[220:223], v[160:163]
    v_add_f32 v237, v237, v239
    v_add_f32 v240, v240, v242
    v_mfma_f32_16x16x32_bf16 v[164:167], v[116:119], v[220:223], v[164:167]
    v_add_f32 v241, v241, v243
    v_add_f32 v244, v244, v246
    s_add_u32 s58, s53, s65
    buffer_load_dwordx4 v[220:223], v14, s[16:19], s58 offen sc1
    s_waitcnt vmcnt(11)
    v_mfma_f32_16x16x32_bf16 v[152:155], v[120:123], v[224:227], v[152:155]
    v_add_f32 v245, v245, v247
    v_add_f32 v232, v232, v236
    v_mfma_f32_16x16x32_bf16 v[156:159], v[124:127], v[224:227], v[156:159]
    v_add_f32 v233, v233, v237
    v_add_f32 v240, v240, v244
    v_mfma_f32_16x16x32_bf16 v[160:163], v[128:131], v[224:227], v[160:163]
    v_add_f32 v241, v241, v245
    v_add_f32 v232, v232, v240
    v_mfma_f32_16x16x32_bf16 v[164:167], v[132:135], v[224:227], v[164:167]
    v_add_f32 v233, v233, v241
    v_add_f32 v248, v232, v16
    s_add_u32 s58, s53, s66
    buffer_load_dwordx4 v[224:227], v14, s[16:19], s58 offen sc1
    s_waitcnt vmcnt(11)
    v_mfma_f32_16x16x32_bf16 v[152:155], v[136:139], v[228:231], v[152:155]
    v_add_f32 v249, v233, v17
    v_mul_f32 v250, v248, v248
    v_mfma_f32_16x16x32_bf16 v[156:159], v[140:143], v[228:231], v[156:159]
    v_mul_f32 v251, v249, v249
    v_fma_f32 v250, v250, v21, v20
    v_mfma_f32_16x16x32_bf16 v[160:163], v[144:147], v[228:231], v[160:163]
    v_fma_f32 v251, v251, v21, v20
    v_mul_f32 v250, v250, v248
    v_mfma_f32_16x16x32_bf16 v[164:167], v[148:151], v[228:231], v[164:167]
    v_mul_f32 v251, v251, v249
    v_exp_f32 v250, v250
    s_add_u32 s58, s53, s67
    buffer_load_dwordx4 v[228:231], v14, s[16:19], s58 offen sc1
    s_cmp_lt_u32 s3, 6
    s_cselect_b32 s24, s76, s86
    s_cselect_b32 s63, s77, s87
    s_and_b32 s25, s63, 0xffff
    s_mov_b32 s26, 0x6c0000
    s_mov_b32 s27, 0x20000
    s_min_u32 s89, s36, 5
    s_mul_i32 s89, s89, 288
    s_mul_i32 s63, s3, 48
    s_add_u32 s89, s89, s63
    s_lshl_b32 s89, s89, 12
    s_lshl_b32 s63, s37, 7
    s_add_u32 s89, s89, s63
    s_cmp_lt_u32 s3, 6
    s_cselect_b32 s89, s89, s49
    s_cselect_b32 s101, 32768, 0
    s_waitcnt vmcnt(11)
    v_mfma_f32_16x16x32_bf16 v[168:171], v[24:27], v[184:187], 0
    v_exp_f32 v251, v251
    v_add_f32 v250, 1.0, v250
    v_mfma_f32_16x16x32_bf16 v[172:175], v[28:31], v[184:187], 0
    v_add_f32 v251, 1.0, v251
    v_rcp_f32 v250, v250
    v_mfma_f32_16x16x32_bf16 v[176:179], v[32:35], v[184:187], 0
    v_rcp_f32 v251, v251
    v_mul_f32 v250, v250, v248
    v_mfma_f32_16x16x32_bf16 v[180:183], v[36:39], v[184:187], 0
    v_mul_f32 v251, v251, v249
    v_cvt_pk_bf16_f32 v248, v250, v251
    s_add_u32 s58, s53, s68
    buffer_load_dwordx4 v[184:187], v14, s[16:19], s58 offen sc1
    s_waitcnt vmcnt(11)
    v_mfma_f32_16x16x32_bf16 v[168:171], v[40:43], v[188:191], v[168:171]
    ds_write_b32 v15, v248 offset:2048
    v_mfma_f32_16x16x32_bf16 v[172:175], v[44:47], v[188:191], v[172:175]
    v_mfma_f32_16x16x32_bf16 v[176:179], v[48:51], v[188:191], v[176:179]
    v_mfma_f32_16x16x32_bf16 v[180:183], v[52:55], v[188:191], v[180:183]
    s_add_u32 s58, s53, s69
    buffer_load_dwordx4 v[188:191], v14, s[16:19], s58 offen sc1
    s_waitcnt vmcnt(11)
    v_mfma_f32_16x16x32_bf16 v[168:171], v[56:59], v[192:195], v[168:171]
    ds_write_b128 v18, v[152:155] offset:0
    ds_write_b128 v18, v[156:159] offset:1024
    v_mfma_f32_16x16x32_bf16 v[172:175], v[60:63], v[192:195], v[172:175]
    ds_write_b128 v18, v[160:163] offset:2048
    ds_write_b128 v18, v[164:167] offset:3072
    v_mfma_f32_16x16x32_bf16 v[176:179], v[64:67], v[192:195], v[176:179]
    v_mfma_f32_16x16x32_bf16 v[180:183], v[68:71], v[192:195], v[180:183]
    s_add_u32 s58, s53, s70
    buffer_load_dwordx4 v[192:195], v14, s[16:19], s58 offen sc1
    s_waitcnt vmcnt(11)
    v_mfma_f32_16x16x32_bf16 v[168:171], v[72:75], v[196:199], v[168:171]
    s_waitcnt lgkmcnt(0)
    s_barrier
    v_mfma_f32_16x16x32_bf16 v[172:175], v[76:79], v[196:199], v[172:175]
    ds_read2st64_b64 v[232:235], v19 offset0:0 offset1:8
    ds_read2st64_b64 v[236:239], v19 offset0:16 offset1:24
    v_mfma_f32_16x16x32_bf16 v[176:179], v[80:83], v[196:199], v[176:179]
    ds_read2st64_b64 v[240:243], v19 offset0:32 offset1:40
    ds_read2st64_b64 v[244:247], v19 offset0:48 offset1:56
    v_mfma_f32_16x16x32_bf16 v[180:183], v[84:87], v[196:199], v[180:183]
    s_cmp_ge_u32 s3, 6
    s_cbranch_scc0 K_nous_d2
    ds_read_b128 v[10:13], v8 offset:2048
    s_waitcnt lgkmcnt(0)
    buffer_store_dwordx4 v[10:13], v9, s[16:19], s97 offen sc1
K_nous_d2:
    s_add_u32 s58, s53, s71
    buffer_load_dwordx4 v[196:199], v14, s[16:19], s58 offen sc1
    s_waitcnt vmcnt(11)
    v_mfma_f32_16x16x32_bf16 v[168:171], v[88:91], v[200:203], v[168:171]
    v_mfma_f32_16x16x32_bf16 v[172:175], v[92:95], v[200:203], v[172:175]
    v_mfma_f32_16x16x32_bf16 v[176:179], v[96:99], v[200:203], v[176:179]
    v_mfma_f32_16x16x32_bf16 v[180:183], v[100:103], v[200:203], v[180:183]
    buffer_load_dwordx4 v[252:255], v4, s[24:27], s89 offen
    s_add_u32 s89, s89, s101
    s_waitcnt vmcnt(11)
    v_mfma_f32_16x16x32_bf16 v[168:171], v[104:107], v[204:207], v[168:171]
    s_waitcnt lgkmcnt(0)
    v_add_f32 v232, v232, v234
    v_mfma_f32_16x16x32_bf16 v[172:175], v[108:111], v[204:207], v[172:175]
    v_add_f32 v233, v233, v235
    v_add_f32 v236, v236, v238
    v_mfma_f32_16x16x32_bf16 v[176:179], v[112:115], v[204:207], v[176:179]
    v_add_f32 v237, v237, v239
    v_add_f32 v240, v240, v242
    v_mfma_f32_16x16x32_bf16 v[180:183], v[116:119], v[204:207], v[180:183]
    v_add_f32 v241, v241, v243
    v_add_f32 v244, v244, v246
    buffer_load_dwordx4 v[252:255], v4, s[24:27], s89 offen
    s_add_u32 s89, s89, s101
    s_waitcnt vmcnt(11)
    v_mfma_f32_16x16x32_bf16 v[168:171], v[120:123], v[208:211], v[168:171]
    v_add_f32 v245, v245, v247
    v_add_f32 v232, v232, v236
    v_mfma_f32_16x16x32_bf16 v[172:175], v[124:127], v[208:211], v[172:175]
    v_add_f32 v233, v233, v237
    v_add_f32 v240, v240, v244
    v_mfma_f32_16x16x32_bf16 v[176:179], v[128:131], v[208:211], v[176:179]
    v_add_f32 v241, v241, v245
    v_add_f32 v232, v232, v240
    v_mfma_f32_16x16x32_bf16 v[180:183], v[132:135], v[208:211], v[180:183]
    v_add_f32 v233, v233, v241
    v_add_f32 v248, v232, v16
    buffer_load_dwordx4 v[252:255], v4, s[24:27], s89 offen
    s_add_u32 s89, s89, s101
    s_waitcnt vmcnt(11)
    v_mfma_f32_16x16x32_bf16 v[168:171], v[136:139], v[212:215], v[168:171]
    v_add_f32 v249, v233, v17
    v_mul_f32 v250, v248, v248
    v_mfma_f32_16x16x32_bf16 v[172:175], v[140:143], v[212:215], v[172:175]
    v_mul_f32 v251, v249, v249
    v_fma_f32 v250, v250, v21, v20
    v_mfma_f32_16x16x32_bf16 v[176:179], v[144:147], v[212:215], v[176:179]
    v_fma_f32 v251, v251, v21, v20
    v_mul_f32 v250, v250, v248
    v_mfma_f32_16x16x32_bf16 v[180:183], v[148:151], v[212:215], v[180:183]
    v_mul_f32 v251, v251, v249
    v_exp_f32 v250, v250
    buffer_load_dwordx4 v[252:255], v4, s[24:27], s89 offen
    s_add_u32 s89, s89, s101
    s_waitcnt vmcnt(11)
    v_mfma_f32_16x16x32_bf16 v[152:155], v[24:27], v[216:219], 0
    v_exp_f32 v251, v251
    v_add_f32 v250, 1.0, v250
    v_mfma_f32_16x16x32_bf16 v[156:159], v[28:31], v[216:219], 0
    v_add_f32 v251, 1.0, v251
    v_rcp_f32 v250, v250
    v_mfma_f32_16x16x32_bf16 v[160:163], v[32:35], v[216:219], 0
    v_rcp_f32 v251, v251
    v_mul_f32 v250, v250, v248
    v_mfma_f32_16x16x32_bf16 v[164:167], v[36:39], v[216:219], 0
    v_mul_f32 v251, v251, v249
    v_cvt_pk_bf16_f32 v248, v250, v251
    buffer_load_dwordx4 v[252:255], v4, s[24:27], s89 offen
    s_add_u32 s89, s89, s101
    s_waitcnt vmcnt(11)
    v_mfma_f32_16x16x32_bf16 v[152:155], v[40:43], v[220:223], v[152:155]
    ds_write_b32 v15, v248 offset:0
    v_mfma_f32_16x16x32_bf16 v[156:159], v[44:47], v[220:223], v[156:159]
    v_mfma_f32_16x16x32_bf16 v[160:163], v[48:51], v[220:223], v[160:163]
    v_mfma_f32_16x16x32_bf16 v[164:167], v[52:55], v[220:223], v[164:167]
    buffer_load_dwordx4 v[252:255], v4, s[24:27], s89 offen
    s_add_u32 s89, s89, s101
    s_waitcnt vmcnt(11)
    v_mfma_f32_16x16x32_bf16 v[152:155], v[56:59], v[224:227], v[152:155]
    ds_write_b128 v18, v[168:171] offset:32768
    ds_write_b128 v18, v[172:175] offset:33792
    v_mfma_f32_16x16x32_bf16 v[156:159], v[60:63], v[224:227], v[156:159]
    ds_write_b128 v18, v[176:179] offset:34816
    ds_write_b128 v18, v[180:183] offset:35840
    v_mfma_f32_16x16x32_bf16 v[160:163], v[64:67], v[224:227], v[160:163]
    v_mfma_f32_16x16x32_bf16 v[164:167], v[68:71], v[224:227], v[164:167]
    s_waitcnt vmcnt(10)
    v_mfma_f32_16x16x32_bf16 v[152:155], v[72:75], v[228:231], v[152:155]
    s_waitcnt lgkmcnt(0)
    s_barrier
    v_mfma_f32_16x16x32_bf16 v[156:159], v[76:79], v[228:231], v[156:159]
    ds_read2st64_b64 v[232:235], v19 offset0:64 offset1:72
    ds_read2st64_b64 v[236:239], v19 offset0:80 offset1:88
    v_mfma_f32_16x16x32_bf16 v[160:163], v[80:83], v[228:231], v[160:163]
    ds_read2st64_b64 v[240:243], v19 offset0:96 offset1:104
    ds_read2st64_b64 v[244:247], v19 offset0:112 offset1:120
    v_mfma_f32_16x16x32_bf16 v[164:167], v[84:87], v[228:231], v[164:167]
    s_cmp_ge_u32 s3, 6
    s_cbranch_scc0 K_nous_d3
    ds_read_b128 v[10:13], v8 offset:0
    s_waitcnt lgkmcnt(0)
    buffer_store_dwordx4 v[10:13], v9, s[16:19], s98 offen sc1
K_nous_d3:
    s_waitcnt vmcnt(9)
    v_mfma_f32_16x16x32_bf16 v[152:155], v[88:91], v[184:187], v[152:155]
    v_mfma_f32_16x16x32_bf16 v[156:159], v[92:95], v[184:187], v[156:159]
    v_mfma_f32_16x16x32_bf16 v[160:163], v[96:99], v[184:187], v[160:163]
    v_mfma_f32_16x16x32_bf16 v[164:167], v[100:103], v[184:187], v[164:167]
    s_waitcnt vmcnt(8)
    v_mfma_f32_16x16x32_bf16 v[152:155], v[104:107], v[188:191], v[152:155]
    s_waitcnt lgkmcnt(0)
    v_add_f32 v232, v232, v234
    v_mfma_f32_16x16x32_bf16 v[156:159], v[108:111], v[188:191], v[156:159]
    v_add_f32 v233, v233, v235
    v_add_f32 v236, v236, v238
    v_mfma_f32_16x16x32_bf16 v[160:163], v[112:115], v[188:191], v[160:163]
    v_add_f32 v237, v237, v239
    v_add_f32 v240, v240, v242
    v_mfma_f32_16x16x32_bf16 v[164:167], v[116:119], v[188:191], v[164:167]
    v_add_f32 v241, v241, v243
    v_add_f32 v244, v244, v246
    s_waitcnt vmcnt(7)
    v_mfma_f32_16x16x32_bf16 v[152:155], v[120:123], v[192:195], v[152:155]
    v_add_f32 v245, v245, v247
    v_add_f32 v232, v232, v236
    v_mfma_f32_16x16x32_bf16 v[156:159], v[124:127], v[192:195], v[156:159]
    v_add_f32 v233, v233, v237
    v_add_f32 v240, v240, v244
    v_mfma_f32_16x16x32_bf16 v[160:163], v[128:131], v[192:195], v[160:163]
    v_add_f32 v241, v241, v245
    v_add_f32 v232, v232, v240
    v_mfma_f32_16x16x32_bf16 v[164:167], v[132:135], v[192:195], v[164:167]
    v_add_f32 v233, v233, v241
    v_add_f32 v248, v232, v16
    s_waitcnt vmcnt(6)
    v_mfma_f32_16x16x32_bf16 v[152:155], v[136:139], v[196:199], v[152:155]
    v_add_f32 v249, v233, v17
    v_mul_f32 v250, v248, v248
    v_mfma_f32_16x16x32_bf16 v[156:159], v[140:143], v[196:199], v[156:159]
    v_mul_f32 v251, v249, v249
    v_fma_f32 v250, v250, v21, v20
    v_mfma_f32_16x16x32_bf16 v[160:163], v[144:147], v[196:199], v[160:163]
    v_fma_f32 v251, v251, v21, v20
    v_mul_f32 v250, v250, v248
    v_mfma_f32_16x16x32_bf16 v[164:167], v[148:151], v[196:199], v[164:167]
    v_mul_f32 v251, v251, v249
    v_exp_f32 v250, v250
    v_exp_f32 v251, v251
    v_add_f32 v250, 1.0, v250
    v_add_f32 v251, 1.0, v251
    v_rcp_f32 v250, v250
    v_rcp_f32 v251, v251
    v_mul_f32 v250, v250, v248
    v_mul_f32 v251, v251, v249
    v_cvt_pk_bf16_f32 v248, v250, v251
    ds_write_b32 v15, v248 offset:2048
    ds_write_b128 v18, v[152:155] offset:0
    ds_write_b128 v18, v[156:159] offset:1024
    ds_write_b128 v18, v[160:163] offset:2048
    ds_write_b128 v18, v[164:167] offset:3072
    s_waitcnt lgkmcnt(0)
    s_barrier
    ds_read2st64_b64 v[232:235], v19 offset0:0 offset1:8
    ds_read2st64_b64 v[236:239], v19 offset0:16 offset1:24
    ds_read2st64_b64 v[240:243], v19 offset0:32 offset1:40
    ds_read2st64_b64 v[244:247], v19 offset0:48 offset1:56
    s_cmp_ge_u32 s3, 6
    s_cbranch_scc0 K_nous_d4
    ds_read_b128 v[10:13], v8 offset:2048
    s_waitcnt lgkmcnt(0)
    buffer_store_dwordx4 v[10:13], v9, s[16:19], s99 offen sc1
K_nous_d4:
    s_waitcnt lgkmcnt(0)
    v_add_f32 v232, v232, v234
    v_add_f32 v233, v233, v235
    v_add_f32 v236, v236, v238
    v_add_f32 v237, v237, v239
    v_add_f32 v240, v240, v242
    v_add_f32 v241, v241, v243
    v_add_f32 v244, v244, v246
    v_add_f32 v245, v245, v247
    v_add_f32 v232, v232, v236
    v_add_f32 v233, v233, v237
    v_add_f32 v240, v240, v244
    v_add_f32 v241, v241, v245
    v_add_f32 v232, v232, v240
    v_add_f32 v233, v233, v241
    v_add_f32 v248, v232, v16
    v_add_f32 v249, v233, v17
    v_mul_f32 v250, v248, v248
    v_mul_f32 v251, v249, v249
    v_fma_f32 v250, v250, v21, v20
    v_fma_f32 v251, v251, v21, v20
    v_mul_f32 v250, v250, v248
    v_mul_f32 v251, v251, v249
    v_exp_f32 v250, v250
    v_exp_f32 v251, v251
    v_add_f32 v250, 1.0, v250
    v_add_f32 v251, 1.0, v251
    v_rcp_f32 v250, v250
    v_rcp_f32 v251, v251
    v_mul_f32 v250, v250, v248
    v_mul_f32 v251, v251, v249
    v_cvt_pk_bf16_f32 v248, v250, v251
    ds_write_b32 v15, v248 offset:0
    s_waitcnt lgkmcnt(0)
    s_barrier
    s_cmp_ge_u32 s3, 6
    s_cbranch_scc0 K_nous_last
    ds_read_b128 v[10:13], v8 offset:0
    s_waitcnt lgkmcnt(0)
    buffer_store_dwordx4 v[10:13], v9, s[16:19], s100 offen sc1
K_nous_last:
    s_mov_b32 s4, s76
    s_and_b32 s5, s77, 0xffff
    s_mov_b32 s6, 0x6c0000
    s_mov_b32 s7, 0x20000
    s_cmp_ge_u32 s3, 6
    s_cbranch_scc1 K_p3a_g
    s_mov_b32 s63, s36
    s_mul_i32 s59, s3, 1179648
    s_lshl_b32 s57, s37, 7
    s_add_u32 s59, s59, s57
    s_add_u32 s40, s63, 0
    s_cmp_ge_u32 s40, 9
    s_cselect_b32 s61, 9, 0
    s_sub_u32 s40, s40, s61
    s_mul_i32 s40, s40, 131072
    s_add_u32 s40, s40, s59
    s_add_u32 s41, s63, 1
    s_cmp_ge_u32 s41, 9
    s_cselect_b32 s61, 9, 0
    s_sub_u32 s41, s41, s61
    s_mul_i32 s41, s41, 131072
    s_add_u32 s41, s41, s59
    s_add_u32 s42, s63, 2
    s_cmp_ge_u32 s42, 9
    s_cselect_b32 s61, 9, 0
    s_sub_u32 s42, s42, s61
    s_mul_i32 s42, s42, 131072
    s_add_u32 s42, s42, s59
    s_add_u32 s43, s63, 3
    s_cmp_ge_u32 s43, 9
    s_cselect_b32 s61, 9, 0
    s_sub_u32 s43, s43, s61
    s_mul_i32 s43, s43, 131072
    s_add_u32 s43, s43, s59
    s_add_u32 s44, s63, 4
    s_cmp_ge_u32 s44, 9
    s_cselect_b32 s61, 9, 0
    s_sub_u32 s44, s44, s61
    s_mul_i32 s44, s44, 131072
    s_add_u32 s44, s44, s59
    s_add_u32 s45, s63, 5
    s_cmp_ge_u32 s45, 9
    s_cselect_b32 s61, 9, 0
    s_sub_u32 s45, s45, s61
    s_mul_i32 s45, s45, 131072
    s_add_u32 s45, s45, s59
    s_add_u32 s46, s63, 6
    s_cmp_ge_u32 s46, 9
    s_cselect_b32 s61, 9, 0
    s_sub_u32 s46, s46, s61
    s_mul_i32 s46, s46, 131072
    s_add_u32 s46, s46, s59
    s_add_u32 s47, s63, 7
    s_cmp_ge_u32 s47, 9
    s_cselect_b32 s61, 9, 0
    s_sub_u32 s47, s47, s61
    s_mul_i32 s47, s47, 131072
    s_add_u32 s47, s47, s59
    s_add_u32 s48, s63, 8
    s_cmp_ge_u32 s48, 9
    s_cselect_b32 s61, 9, 0
    s_sub_u32 s48, s48, s61
    s_mul_i32 s48, s48, 131072
    s_add_u32 s48, s48, s59
    s_add_u32 m0, s38, 0
    s_mov_b32 s62, s40
    buffer_load_dwordx4 v4, s[4:7], s62 offen lds
    s_add_u32 m0, s38, 1024
    s_add_u32 s62, s62, 32768
    buffer_load_dwordx4 v4, s[4:7], s62 offen lds
    s_add_u32 m0, s38, 2048
    s_add_u32 s62, s62, 32768
    buffer_load_dwordx4 v4, s[4:7], s62 offen lds
    s_add_u32 m0, s38, 3072
    s_add_u32 s62, s62, 32768
    buffer_load_dwordx4 v4, s[4:7], s62 offen lds
    s_add_u32 m0, s38, 4096
    s_mov_b32 s62, s41
    buffer_load_dwordx4 v4, s[4:7], s62 offen lds
    s_add_u32 m0, s38, 5120
    s_add_u32 s62, s62, 32768
    buffer_load_dwordx4 v4, s[4:7], s62 offen lds
    s_add_u32 m0, s38, 6144
    s_add_u32 s62, s62, 32768
    buffer_load_dwordx4 v4, s[4:7], s62 offen lds
    s_add_u32 m0, s38, 7168
    s_add_u32 s62, s62, 32768
    buffer_load_dwordx4 v4, s[4:7], s62 offen lds
    s_add_u32 m0, s38, 8192
    s_mov_b32 s62, s42
    buffer_load_dwordx4 v4, s[4:7], s62 offen lds
    s_add_u32 m0, s38, 9216
    s_add_u32 s62, s62, 32768
    buffer_load_dwordx4 v4, s[4:7], s62 offen lds
    s_add_u32 m0, s38, 10240
    s_add_u32 s62, s62, 32768
    buffer_load_dwordx4 v4, s[4:7], s62 offen lds
    s_add_u32 m0, s38, 11264
    s_add_u32 s62, s62, 32768
    buffer_load_dwordx4 v4, s[4:7], s62 offen lds
    s_add_u32 m0, s39, 0
    s_mov_b32 s62, s43
    buffer_load_dwordx4 v4, s[4:7], s62 offen lds
    s_add_u32 m0, s39, 1024
    s_add_u32 s62, s62, 32768
    buffer_load_dwordx4 v4, s[4:7], s62 offen lds
    s_add_u32 m0, s39, 2048
    s_add_u32 s62, s62, 32768
    buffer_load_dwordx4 v4, s[4:7], s62 offen lds
    s_add_u32 m0, s39, 3072
    s_add_u32 s62, s62, 32768
    buffer_load_dwordx4 v4, s[4:7], s62 offen lds
    s_add_u32 m0, s39, 32768
    s_mov_b32 s62, s44
    buffer_load_dwordx4 v4, s[4:7], s62 offen lds
    s_add_u32 m0, s39, 33792
    s_add_u32 s62, s62, 32768
    buffer_load_dwordx4 v4, s[4:7], s62 offen lds
    s_add_u32 m0, s39, 34816
    s_add_u32 s62, s62, 32768
    buffer_load_dwordx4 v4, s[4:7], s62 offen lds
    s_add_u32 m0, s39, 35840
    s_add_u32 s62, s62, 32768
    buffer_load_dwordx4 v4, s[4:7], s62 offen lds
K_p3a_g:
    s_cmp_ge_u32 s3, 6
    s_cbranch_scc0 K_nodrain
    s_waitcnt vmcnt(0)
K_nodrain:
    s_barrier
    s_cmp_eq_u32 s3, 7
    s_cbranch_scc0 K_p3
    s_mov_b32 s60, 0
Ku_nonce:
    v_readfirstlane_b32 s20, v6
    v_readfirstlane_b32 s21, v7
    s_nop 0
    s_cmp_lg_u32 s21, 0
    s_cbranch_scc1 Ku_nonceok
    s_add_u32 s60, s60, 1
    s_cmp_lt_u32 s60, 262144
    s_cbranch_scc0 Ku_nonceok
    v_mov_b32 v240, 0
    global_load_dwordx2 v[6:7], v240, s[84:85] sc1
    s_waitcnt vmcnt(0)
    s_branch Ku_nonce
Ku_nonceok:
    s_lshl_b32 s58, s33, 5
    s_add_u32 s58, s58, s34
    s_mul_i32 s58, s58, 32
    s_add_u32 s58, s58, 13598720
    v_mov_b32 v240, s20
    v_mov_b32 v241, s21
    v_mov_b32 v242, 0
    s_mov_b64 s[22:23], exec
    s_mov_b64 exec, 1
    buffer_store_dwordx2 v[240:241], v242, s[16:19], s58 offen sc1
    s_mov_b64 exec, s[22:23]
    s_branch K_p3
K_fft:
    s_waitcnt vmcnt(0)
    s_barrier
    s_cmp_eq_u32 s3, 7
    s_cbranch_scc0 K_nofl1f
    s_mov_b32 s60, 0
Kf_nonce:
    v_readfirstlane_b32 s20, v6
    v_readfirstlane_b32 s21, v7
    s_nop 0
    s_cmp_lg_u32 s21, 0
    s_cbranch_scc1 Kf_nonceok
    s_add_u32 s60, s60, 1
    s_cmp_lt_u32 s60, 262144
    s_cbranch_scc0 Kf_nonceok
    v_mov_b32 v240, 0
    global_load_dwordx2 v[6:7], v240, s[84:85] sc1
    s_waitcnt vmcnt(0)
    s_branch Kf_nonce
Kf_nonceok:
    s_mul_i32 s58, s2, 32
    s_add_u32 s58, s58, 13565952
    v_mov_b32 v240, s20
    v_mov_b32 v241, s21
    v_mov_b32 v242, 0
    s_mov_b64 s[22:23], exec
    s_mov_b64 exec, 1
    buffer_store_dwordx2 v[240:241], v242, s[16:19], s58 offen sc1
    s_mov_b64 exec, s[22:23]
K_nofl1f:
    v_and_b32 v104, 31, v1
    v_lshrrev_b32 v105, 5, v1
    v_cvt_f32_u32 v106, v104
    v_cvt_f32_u32 v140, v105
    v_lshlrev_b32 v110, 4, v1
    v_add_u32 v110, 131072, v110
    s_cmp_ge_u32 s3, 4
    s_cbranch_scc0 FT_notg
    s_sub_u32 s44, s3, 4
    s_and_b32 s45, s44, 1
    s_lshl_b32 s45, s45, 5
    s_lshr_b32 s46, s44, 1
    s_add_u32 s45, s45, s46
    v_lshlrev_b32 v111, 2, v105
    v_add_u32 v111, s45, v111
    v_cvt_f32_u32 v111, v111
    v_mul_f32 v107, 0x3c800000, v106
    v_add_f32 v108, 0x00000000, v111
    v_mul_f32 v108, v108, v107
    v_fract_f32 v109, v108
    v_cos_f32 v112, v109
    v_sin_f32 v120, v109
    v_add_f32 v108, 0x40000000, v111
    v_mul_f32 v108, v108, v107
    v_fract_f32 v109, v108
    v_cos_f32 v113, v109
    v_sin_f32 v121, v109
    v_add_f32 v108, 0x41000000, v111
    v_mul_f32 v108, v108, v107
    v_fract_f32 v109, v108
    v_cos_f32 v114, v109
    v_sin_f32 v122, v109
    v_add_f32 v108, 0x41200000, v111
    v_mul_f32 v108, v108, v107
    v_fract_f32 v109, v108
    v_cos_f32 v115, v109
    v_sin_f32 v123, v109
    v_add_f32 v108, 0x41800000, v111
    v_mul_f32 v108, v108, v107
    v_fract_f32 v109, v108
    v_cos_f32 v116, v109
    v_sin_f32 v124, v109
    v_add_f32 v108, 0x41900000, v111
    v_mul_f32 v108, v108, v107
    v_fract_f32 v109, v108
    v_cos_f32 v117, v109
    v_sin_f32 v125, v109
    v_add_f32 v108, 0x41c00000, v111
    v_mul_f32 v108, v108, v107
    v_fract_f32 v109, v108
    v_cos_f32 v118, v109
    v_sin_f32 v126, v109
    v_add_f32 v108, 0x41d00000, v111
    v_mul_f32 v108, v108, v107
    v_fract_f32 v109, v108
    v_cos_f32 v119, v109
    v_sin_f32 v127, v109
    v_cvt_pk_bf16_f32 v128, v112, v113
    v_cvt_pk_bf16_f32 v132, -v120, -v121
    v_cvt_pk_bf16_f32 v136, v120, v121
    v_cvt_pk_bf16_f32 v129, v114, v115
    v_cvt_pk_bf16_f32 v133, -v122, -v123
    v_cvt_pk_bf16_f32 v137, v122, v123
    v_cvt_pk_bf16_f32 v130, v116, v117
    v_cvt_pk_bf16_f32 v134, -v124, -v125
    v_cvt_pk_bf16_f32 v138, v124, v125
    v_cvt_pk_bf16_f32 v131, v118, v119
    v_cvt_pk_bf16_f32 v135, -v126, -v127
    v_cvt_pk_bf16_f32 v139, v126, v127
    s_mul_i32 s44, s44, 3072
    v_add_u32 v111, s44, v110
    ds_write_b128 v111, v[128:131] offset:0
    ds_write_b128 v111, v[132:135] offset:1024
    ds_write_b128 v111, v[136:139] offset:2048
    s_branch FT_gdone
FT_notg:
    s_cmp_lt_u32 s3, 2
    s_cbranch_scc0 FT_gdone
    s_lshl_b32 s44, s3, 4
    v_lshlrev_b32 v111, 2, v105
    v_add_u32 v111, s44, v111
    v_cvt_f32_u32 v111, v111
    v_mul_f32 v107, 0x3d000000, v106
    v_add_f32 v108, 0x00000000, v111
    v_mul_f32 v108, v108, v107
    v_fract_f32 v109, v108
    v_cos_f32 v112, v109
    v_sin_f32 v120, v109
    v_add_f32 v108, 0x3f800000, v111
    v_mul_f32 v108, v108, v107
    v_fract_f32 v109, v108
    v_cos_f32 v113, v109
    v_sin_f32 v121, v109
    v_add_f32 v108, 0x40000000, v111
    v_mul_f32 v108, v108, v107
    v_fract_f32 v109, v108
    v_cos_f32 v114, v109
    v_sin_f32 v122, v109
    v_add_f32 v108, 0x40400000, v111
    v_mul_f32 v108, v108, v107
    v_fract_f32 v109, v108
    v_cos_f32 v115, v109
    v_sin_f32 v123, v109
    v_add_f32 v108, 0x41000000, v111
    v_mul_f32 v108, v108, v107
    v_fract_f32 v109, v108
    v_cos_f32 v116, v109
    v_sin_f32 v124, v109
    v_add_f32 v108, 0x41100000, v111
    v_mul_f32 v108, v108, v107
    v_fract_f32 v109, v108
    v_cos_f32 v117, v109
    v_sin_f32 v125, v109
    v_add_f32 v108, 0x41200000, v111
    v_mul_f32 v108, v108, v107
    v_fract_f32 v109, v108
    v_cos_f32 v118, v109
    v_sin_f32 v126, v109
    v_add_f32 v108, 0x41300000, v111
    v_mul_f32 v108, v108, v107
    v_fract_f32 v109, v108
    v_cos_f32 v119, v109
    v_sin_f32 v127, v109
    v_cvt_pk_bf16_f32 v128, v112, v113
    v_cvt_pk_bf16_f32 v132, -v120, -v121
    v_cvt_pk_bf16_f32 v129, v114, v115
    v_cvt_pk_bf16_f32 v133, -v122, -v123
    v_cvt_pk_bf16_f32 v130, v116, v117
    v_cvt_pk_bf16_f32 v134, -v124, -v125
    v_cvt_pk_bf16_f32 v131, v118, v119
    v_cvt_pk_bf16_f32 v135, -v126, -v127
    s_lshl_b32 s44, s3, 11
    v_add_u32 v111, s44, v110
    ds_write_b128 v111, v[128:131] offset:12288
    ds_write_b128 v111, v[132:135] offset:13312
FT_gdone:
    s_lshr_b32 s44, s3, 2
    s_and_b32 s45, s3, 3
    s_lshl_b32 s46, s44, 5
    v_add_u32 v107, s46, v104
    v_cvt_f32_u32 v107, v107
    v_mul_f32 v107, 0x3a000000, v107
    s_lshl_b32 s46, s45, 3
    v_lshlrev_b32 v108, 2, v105
    v_add_u32 v108, s46, v108
    v_cvt_f32_u32 v108, v108
    v_mul_f32 v108, v108, v107
    v_cos_f32 v136, v108
    v_sin_f32 v128, v108
    v_add_f32 v108, v108, v107
    v_cos_f32 v137, v108
    v_sin_f32 v129, v108
    v_add_f32 v108, v108, v107
    v_cos_f32 v138, v108
    v_sin_f32 v130, v108
    v_add_f32 v108, v108, v107
    v_cos_f32 v139, v108
    v_sin_f32 v131, v108
    v_mul_f32 v136, 0x35cccccd, v136
    v_mul_f32 v128, 0x35cccccd, v128
    v_mul_f32 v137, 0x35cccccd, v137
    v_mul_f32 v129, 0x35cccccd, v129
    v_mul_f32 v138, 0x35cccccd, v138
    v_mul_f32 v130, 0x35cccccd, v130
    v_mul_f32 v139, 0x35cccccd, v139
    v_mul_f32 v131, 0x35cccccd, v131
    s_lshl_b32 s46, s3, 11
    v_add_u32 v111, s46, v110
    ds_write_b128 v111, v[136:139] offset:16384
    ds_write_b128 v111, v[128:131] offset:17408
    v_mul_f32 v107, 0x3d000000, v106
    v_fmaak_f32 v108, 4.0, v140, 0x00000000
    v_mul_f32 v108, v108, v107
    v_fract_f32 v109, v108
    v_cos_f32 v112, v109
    v_sin_f32 v120, v109
    v_add_f32 v108, v108, v107
    v_fract_f32 v109, v108
    v_cos_f32 v113, v109
    v_sin_f32 v121, v109
    v_add_f32 v108, v108, v107
    v_fract_f32 v109, v108
    v_cos_f32 v114, v109
    v_sin_f32 v122, v109
    v_add_f32 v108, v108, v107
    v_fract_f32 v109, v108
    v_cos_f32 v115, v109
    v_sin_f32 v123, v109
    v_cvt_pk_bf16_f32 v168, v112, v120
    v_cvt_pk_bf16_f32 v172, -v120, v112
    v_cvt_pk_bf16_f32 v169, v113, v121
    v_cvt_pk_bf16_f32 v173, -v121, v113
    v_cvt_pk_bf16_f32 v170, v114, v122
    v_cvt_pk_bf16_f32 v174, -v122, v114
    v_cvt_pk_bf16_f32 v171, v115, v123
    v_cvt_pk_bf16_f32 v175, -v123, v115
    v_fmaak_f32 v108, 4.0, v140, 0x41000000
    v_mul_f32 v108, v108, v107
    v_fract_f32 v109, v108
    v_cos_f32 v112, v109
    v_sin_f32 v120, v109
    v_add_f32 v108, v108, v107
    v_fract_f32 v109, v108
    v_cos_f32 v113, v109
    v_sin_f32 v121, v109
    v_add_f32 v108, v108, v107
    v_fract_f32 v109, v108
    v_cos_f32 v114, v109
    v_sin_f32 v122, v109
    v_add_f32 v108, v108, v107
    v_fract_f32 v109, v108
    v_cos_f32 v115, v109
    v_sin_f32 v123, v109
    v_cvt_pk_bf16_f32 v176, v112, v120
    v_cvt_pk_bf16_f32 v180, -v120, v112
    v_cvt_pk_bf16_f32 v177, v113, v121
    v_cvt_pk_bf16_f32 v181, -v121, v113
    v_cvt_pk_bf16_f32 v178, v114, v122
    v_cvt_pk_bf16_f32 v182, -v122, v114
    v_cvt_pk_bf16_f32 v179, v115, v123
    v_cvt_pk_bf16_f32 v183, -v123, v115
    v_fmaak_f32 v108, 4.0, v140, 0x41800000
    v_mul_f32 v108, v108, v107
    v_fract_f32 v109, v108
    v_cos_f32 v112, v109
    v_sin_f32 v120, v109
    v_add_f32 v108, v108, v107
    v_fract_f32 v109, v108
    v_cos_f32 v113, v109
    v_sin_f32 v121, v109
    v_add_f32 v108, v108, v107
    v_fract_f32 v109, v108
    v_cos_f32 v114, v109
    v_sin_f32 v122, v109
    v_add_f32 v108, v108, v107
    v_fract_f32 v109, v108
    v_cos_f32 v115, v109
    v_sin_f32 v123, v109
    v_cvt_pk_bf16_f32 v184, v112, v120
    v_cvt_pk_bf16_f32 v188, -v120, v112
    v_cvt_pk_bf16_f32 v185, v113, v121
    v_cvt_pk_bf16_f32 v189, -v121, v113
    v_cvt_pk_bf16_f32 v186, v114, v122
    v_cvt_pk_bf16_f32 v190, -v122, v114
    v_cvt_pk_bf16_f32 v187, v115, v123
    v_cvt_pk_bf16_f32 v191, -v123, v115
    v_fmaak_f32 v108, 4.0, v140, 0x41c00000
    v_mul_f32 v108, v108, v107
    v_fract_f32 v109, v108
    v_cos_f32 v112, v109
    v_sin_f32 v120, v109
    v_add_f32 v108, v108, v107
    v_fract_f32 v109, v108
    v_cos_f32 v113, v109
    v_sin_f32 v121, v109
    v_add_f32 v108, v108, v107
    v_fract_f32 v109, v108
    v_cos_f32 v114, v109
    v_sin_f32 v122, v109
    v_add_f32 v108, v108, v107
    v_fract_f32 v109, v108
    v_cos_f32 v115, v109
    v_sin_f32 v123, v109
    v_cvt_pk_bf16_f32 v192, v112, v120
    v_cvt_pk_bf16_f32 v196, -v120, v112
    v_cvt_pk_bf16_f32 v193, v113, v121
    v_cvt_pk_bf16_f32 v197, -v121, v113
    v_cvt_pk_bf16_f32 v194, v114, v122
    v_cvt_pk_bf16_f32 v198, -v122, v114
    v_cvt_pk_bf16_f32 v195, v115, v123
    v_cvt_pk_bf16_f32 v199, -v123, v115
    v_mul_f32 v107, 0x3a000000, v106
    v_fmaak_f32 v108, 4.0, v140, 0x00000000
    v_mul_f32 v108, v108, v107
    v_cos_f32 v200, v108
    v_sin_f32 v204, v108
    v_add_f32 v108, v108, v107
    v_cos_f32 v201, v108
    v_sin_f32 v205, v108
    v_add_f32 v108, v108, v107
    v_cos_f32 v202, v108
    v_sin_f32 v206, v108
    v_add_f32 v108, v108, v107
    v_cos_f32 v203, v108
    v_sin_f32 v207, v108
    v_xor_b32 v204, 0x80000000, v204
    v_xor_b32 v205, 0x80000000, v205
    v_xor_b32 v206, 0x80000000, v206
    v_xor_b32 v207, 0x80000000, v207
    v_fmaak_f32 v108, 4.0, v140, 0x41000000
    v_mul_f32 v108, v108, v107
    v_cos_f32 v208, v108
    v_sin_f32 v212, v108
    v_add_f32 v108, v108, v107
    v_cos_f32 v209, v108
    v_sin_f32 v213, v108
    v_add_f32 v108, v108, v107
    v_cos_f32 v210, v108
    v_sin_f32 v214, v108
    v_add_f32 v108, v108, v107
    v_cos_f32 v211, v108
    v_sin_f32 v215, v108
    v_xor_b32 v212, 0x80000000, v212
    v_xor_b32 v213, 0x80000000, v213
    v_xor_b32 v214, 0x80000000, v214
    v_xor_b32 v215, 0x80000000, v215
    v_fmaak_f32 v108, 4.0, v140, 0x41800000
    v_mul_f32 v108, v108, v107
    v_cos_f32 v216, v108
    v_sin_f32 v220, v108
    v_add_f32 v108, v108, v107
    v_cos_f32 v217, v108
    v_sin_f32 v221, v108
    v_add_f32 v108, v108, v107
    v_cos_f32 v218, v108
    v_sin_f32 v222, v108
    v_add_f32 v108, v108, v107
    v_cos_f32 v219, v108
    v_sin_f32 v223, v108
    v_xor_b32 v220, 0x80000000, v220
    v_xor_b32 v221, 0x80000000, v221
    v_xor_b32 v222, 0x80000000, v222
    v_xor_b32 v223, 0x80000000, v223
    v_fmaak_f32 v108, 4.0, v140, 0x41c00000
    v_mul_f32 v108, v108, v107
    v_cos_f32 v224, v108
    v_sin_f32 v228, v108
    v_add_f32 v108, v108, v107
    v_cos_f32 v225, v108
    v_sin_f32 v229, v108
    v_add_f32 v108, v108, v107
    v_cos_f32 v226, v108
    v_sin_f32 v230, v108
    v_add_f32 v108, v108, v107
    v_cos_f32 v227, v108
    v_sin_f32 v231, v108
    v_xor_b32 v228, 0x80000000, v228
    v_xor_b32 v229, 0x80000000, v229
    v_xor_b32 v230, 0x80000000, v230
    v_xor_b32 v231, 0x80000000, v231
    v_fmaak_f32 v108, 4.0, v140, 0x42000000
    v_mul_f32 v108, v108, v107
    v_cos_f32 v72, v108
    v_sin_f32 v76, v108
    v_add_f32 v108, v108, v107
    v_cos_f32 v73, v108
    v_sin_f32 v77, v108
    v_add_f32 v108, v108, v107
    v_cos_f32 v74, v108
    v_sin_f32 v78, v108
    v_add_f32 v108, v108, v107
    v_cos_f32 v75, v108
    v_sin_f32 v79, v108
    v_xor_b32 v76, 0x80000000, v76
    v_xor_b32 v77, 0x80000000, v77
    v_xor_b32 v78, 0x80000000, v78
    v_xor_b32 v79, 0x80000000, v79
    v_fmaak_f32 v108, 4.0, v140, 0x42200000
    v_mul_f32 v108, v108, v107
    v_cos_f32 v80, v108
    v_sin_f32 v84, v108
    v_add_f32 v108, v108, v107
    v_cos_f32 v81, v108
    v_sin_f32 v85, v108
    v_add_f32 v108, v108, v107
    v_cos_f32 v82, v108
    v_sin_f32 v86, v108
    v_add_f32 v108, v108, v107
    v_cos_f32 v83, v108
    v_sin_f32 v87, v108
    v_xor_b32 v84, 0x80000000, v84
    v_xor_b32 v85, 0x80000000, v85
    v_xor_b32 v86, 0x80000000, v86
    v_xor_b32 v87, 0x80000000, v87
    v_fmaak_f32 v108, 4.0, v140, 0x42400000
    v_mul_f32 v108, v108, v107
    v_cos_f32 v88, v108
    v_sin_f32 v92, v108
    v_add_f32 v108, v108, v107
    v_cos_f32 v89, v108
    v_sin_f32 v93, v108
    v_add_f32 v108, v108, v107
    v_cos_f32 v90, v108
    v_sin_f32 v94, v108
    v_add_f32 v108, v108, v107
    v_cos_f32 v91, v108
    v_sin_f32 v95, v108
    v_xor_b32 v92, 0x80000000, v92
    v_xor_b32 v93, 0x80000000, v93
    v_xor_b32 v94, 0x80000000, v94
    v_xor_b32 v95, 0x80000000, v95
    v_fmaak_f32 v108, 4.0, v140, 0x42600000
    v_mul_f32 v108, v108, v107
    v_cos_f32 v96, v108
    v_sin_f32 v100, v108
    v_add_f32 v108, v108, v107
    v_cos_f32 v97, v108
    v_sin_f32 v101, v108
    v_add_f32 v108, v108, v107
    v_cos_f32 v98, v108
    v_sin_f32 v102, v108
    v_add_f32 v108, v108, v107
    v_cos_f32 v99, v108
    v_sin_f32 v103, v108
    v_xor_b32 v100, 0x80000000, v100
    v_xor_b32 v101, 0x80000000, v101
    v_xor_b32 v102, 0x80000000, v102
    v_xor_b32 v103, 0x80000000, v103
    v_lshlrev_b32 v8, 4, v0
    v_lshlrev_b32 v9, 4, v1
    v_add_u32 v9, 131072, v9
    s_lshr_b32 s44, s3, 1
    s_lshl_b32 s44, s44, 14
    s_and_b32 s45, s3, 1
    s_lshl_b32 s45, s45, 2
    s_add_u32 s44, s44, s45
    v_lshlrev_b32 v109, 3, v104
    v_lshl_add_u32 v10, v105, 11, v109
    v_add_u32 v10, s44, v10
    v_lshl_add_u32 v11, v105, 10, v109
    v_add_u32 v11, s44, v11
    v_add_u32 v11, 65536, v11
    v_lshrrev_b32 v109, 3, v104
    s_and_b32 s45, s3, 3
    v_xor_b32 v109, s45, v109
    v_lshlrev_b32 v109, 2, v109
    v_lshl_add_u32 v109, v104, 4, v109
    v_lshl_add_u32 v12, v105, 12, v109
    s_lshr_b32 s45, s3, 2
    s_lshl_b32 s45, s45, 15
    v_add_u32 v12, s45, v12
    s_waitcnt lgkmcnt(0)
    s_barrier
    ds_read_b128 v[232:235], v9 offset:0
    ds_read_b128 v[236:239], v9 offset:1024
    ds_read_b128 v[240:243], v9 offset:2048
    ds_read_b128 v[244:247], v9 offset:6144
    ds_read_b128 v[248:251], v9 offset:7168
    ds_read_b128 v[252:255], v9 offset:8192
    s_waitcnt lgkmcnt(0)
    s_cmp_eq_u32 s3, 7
    s_cbranch_scc0 K_fftnp
    s_mov_b32 s58, 13565952
    v_mul_u32_u24 v104, 32, v1
    v_add_u32 v105, 2048, v104
    v_add_u32 v106, 4096, v104
    v_add_u32 v107, 6144, v104
    s_mov_b32 s60, 0
K_poll_fft:
    buffer_load_dwordx2 v[108:109], v104, s[16:19], s58 offen sc1
    buffer_load_dwordx2 v[110:111], v105, s[16:19], s58 offen sc1
    buffer_load_dwordx2 v[112:113], v106, s[16:19], s58 offen sc1
    buffer_load_dwordx2 v[114:115], v107, s[16:19], s58 offen sc1
    s_waitcnt vmcnt(0)
    v_cmp_eq_u64 s[54:55], v[108:109], s[20:21]
    s_nop 0
    s_mov_b64 s[56:57], s[54:55]
    v_cmp_eq_u64 s[54:55], v[110:111], s[20:21]
    s_nop 0
    s_and_b64 s[56:57], s[56:57], s[54:55]
    v_cmp_eq_u64 s[54:55], v[112:113], s[20:21]
    s_nop 0
    s_and_b64 s[56:57], s[56:57], s[54:55]
    v_cmp_eq_u64 s[54:55], v[114:115], s[20:21]
    s_nop 0
    s_and_b64 s[56:57], s[56:57], s[54:55]
    s_cmp_eq_u64 s[56:57], exec
    s_cbranch_scc1 K_pollok_fft
    s_add_u32 s60, s60, 1
    s_cmp_lt_u32 s60, 262144
    s_cbranch_scc0 K_pollok_fft
    s_sleep 1
    s_branch K_poll_fft
K_pollok_fft:
K_fftnp:
    s_barrier
    s_waitcnt vmcnt(0)
    v_lshlrev_b32 v13, 4, v1
    s_lshl_b32 s41, s35, 16
    s_lshl_b32 s44, s3, 10
    s_add_u32 s42, s41, s44
    s_add_u32 m0, s44, 0
    s_add_u32 s43, s42, 2621440
    buffer_load_dwordx4 v13, s[16:19], s43 offen sc1 lds
    s_add_u32 m0, s44, 8192
    s_add_u32 s43, s42, 2629632
    buffer_load_dwordx4 v13, s[16:19], s43 offen sc1 lds
    s_add_u32 m0, s44, 16384
    s_add_u32 s43, s42, 2637824
    buffer_load_dwordx4 v13, s[16:19], s43 offen sc1 lds
    s_add_u32 m0, s44, 24576
    s_add_u32 s43, s42, 2646016
    buffer_load_dwordx4 v13, s[16:19], s43 offen sc1 lds
    s_add_u32 m0, s44, 32768
    s_add_u32 s43, s42, 2654208
    buffer_load_dwordx4 v13, s[16:19], s43 offen sc1 lds
    s_add_u32 m0, s44, 40960
    s_add_u32 s43, s42, 2662400
    buffer_load_dwordx4 v13, s[16:19], s43 offen sc1 lds
    s_add_u32 m0, s44, 49152
    s_add_u32 s43, s42, 2670592
    buffer_load_dwordx4 v13, s[16:19], s43 offen sc1 lds
    s_add_u32 m0, s44, 57344
    s_add_u32 s43, s42, 2678784
    buffer_load_dwordx4 v13, s[16:19], s43 offen sc1 lds
    s_waitcnt vmcnt(0)
    s_barrier
    s_add_u32 m0, s44, 65536
    s_add_u32 s43, s42, 5242880
    buffer_load_dwordx4 v13, s[16:19], s43 offen sc1 lds
    s_add_u32 m0, s44, 73728
    s_add_u32 s43, s42, 5251072
    buffer_load_dwordx4 v13, s[16:19], s43 offen sc1 lds
    s_add_u32 m0, s44, 81920
    s_add_u32 s43, s42, 5259264
    buffer_load_dwordx4 v13, s[16:19], s43 offen sc1 lds
    s_add_u32 m0, s44, 90112
    s_add_u32 s43, s42, 5267456
    buffer_load_dwordx4 v13, s[16:19], s43 offen sc1 lds
    s_add_u32 m0, s44, 98304
    s_add_u32 s43, s42, 5275648
    buffer_load_dwordx4 v13, s[16:19], s43 offen sc1 lds
    s_add_u32 m0, s44, 106496
    s_add_u32 s43, s42, 5283840
    buffer_load_dwordx4 v13, s[16:19], s43 offen sc1 lds
    s_add_u32 m0, s44, 114688
    s_add_u32 s43, s42, 5292032
    buffer_load_dwordx4 v13, s[16:19], s43 offen sc1 lds
    s_add_u32 m0, s44, 122880
    s_add_u32 s43, s42, 5300224
    buffer_load_dwordx4 v13, s[16:19], s43 offen sc1 lds
    ds_read2st64_b32 v[14:15], v10 offset0:0 offset1:2
    ds_read2st64_b32 v[16:17], v10 offset0:4 offset1:6
    ds_read2st64_b32 v[18:19], v10 offset0:16 offset1:18
    ds_read2st64_b32 v[20:21], v10 offset0:20 offset1:22
    ds_read2st64_b32 v[22:23], v10 offset0:32 offset1:34
    ds_read2st64_b32 v[24:25], v10 offset0:36 offset1:38
    ds_read2st64_b32 v[26:27], v10 offset0:48 offset1:50
    ds_read2st64_b32 v[28:29], v10 offset0:52 offset1:54
    s_waitcnt lgkmcnt(6)
    v_mfma_f32_32x32x16_bf16 v[104:119], v[14:17], v[168:171], 0
    v_mfma_f32_32x32x16_bf16 v[120:135], v[14:17], v[172:175], 0
    ds_read2st64_b32 v[14:15], v10 offset0:1 offset1:3
    ds_read2st64_b32 v[16:17], v10 offset0:5 offset1:7
    s_waitcnt lgkmcnt(6)
    v_mfma_f32_32x32x16_bf16 v[104:119], v[18:21], v[176:179], v[104:119]
    v_mfma_f32_32x32x16_bf16 v[120:135], v[18:21], v[180:183], v[120:135]
    ds_read2st64_b32 v[18:19], v10 offset0:17 offset1:19
    ds_read2st64_b32 v[20:21], v10 offset0:21 offset1:23
    s_waitcnt lgkmcnt(6)
    v_mfma_f32_32x32x16_bf16 v[104:119], v[22:25], v[184:187], v[104:119]
    v_mfma_f32_32x32x16_bf16 v[120:135], v[22:25], v[188:191], v[120:135]
    ds_read2st64_b32 v[22:23], v10 offset0:33 offset1:35
    ds_read2st64_b32 v[24:25], v10 offset0:37 offset1:39
    s_waitcnt lgkmcnt(6)
    v_mfma_f32_32x32x16_bf16 v[104:119], v[26:29], v[192:195], v[104:119]
    v_mfma_f32_32x32x16_bf16 v[120:135], v[26:29], v[196:199], v[120:135]
    ds_read2st64_b32 v[26:27], v10 offset0:49 offset1:51
    ds_read2st64_b32 v[28:29], v10 offset0:53 offset1:55
    s_waitcnt lgkmcnt(6)
    v_mfma_f32_32x32x16_bf16 v[136:151], v[14:17], v[168:171], 0
    v_mfma_f32_32x32x16_bf16 v[152:167], v[14:17], v[172:175], 0
    s_nop 5
    v_mul_f32 v30, v104, v200
    v_mul_f32 v34, v104, v204
    v_mul_f32 v31, v105, v201
    v_mul_f32 v35, v105, v205
    v_mul_f32 v32, v106, v202
    v_mul_f32 v36, v106, v206
    v_mul_f32 v33, v107, v203
    v_mul_f32 v37, v107, v207
    v_fma_f32 v30, -v120, v204, v30
    v_fmac_f32 v34, v120, v200
    v_fma_f32 v31, -v121, v205, v31
    v_fmac_f32 v35, v121, v201
    s_waitcnt lgkmcnt(4)
    v_mfma_f32_32x32x16_bf16 v[136:151], v[18:21], v[176:179], v[136:151]
    v_fma_f32 v32, -v122, v206, v32
    v_fmac_f32 v36, v122, v202
    v_fma_f32 v33, -v123, v207, v33
    v_fmac_f32 v37, v123, v203
    v_cvt_pk_bf16_f32 v40, v30, v32
    v_cvt_pk_bf16_f32 v48, v31, v33
    v_cvt_pk_bf16_f32 v44, v34, v36
    v_cvt_pk_bf16_f32 v52, v35, v37
    v_mul_f32 v30, v108, v208
    v_mul_f32 v34, v108, v212
    v_mul_f32 v31, v109, v209
    v_mfma_f32_32x32x16_bf16 v[152:167], v[18:21], v[180:183], v[152:167]
    v_mul_f32 v35, v109, v213
    v_mul_f32 v32, v110, v210
    v_mul_f32 v36, v110, v214
    v_mul_f32 v33, v111, v211
    v_mul_f32 v37, v111, v215
    v_fma_f32 v30, -v124, v212, v30
    v_fmac_f32 v34, v124, v208
    v_fma_f32 v31, -v125, v213, v31
    v_fmac_f32 v35, v125, v209
    v_fma_f32 v32, -v126, v214, v32
    v_fmac_f32 v36, v126, v210
    v_fma_f32 v33, -v127, v215, v33
    s_waitcnt lgkmcnt(2)
    v_mfma_f32_32x32x16_bf16 v[136:151], v[22:25], v[184:187], v[136:151]
    v_fmac_f32 v37, v127, v211
    v_cvt_pk_bf16_f32 v41, v30, v32
    v_cvt_pk_bf16_f32 v49, v31, v33
    v_cvt_pk_bf16_f32 v45, v34, v36
    v_cvt_pk_bf16_f32 v53, v35, v37
    v_mul_f32 v30, v112, v216
    v_mul_f32 v34, v112, v220
    v_mul_f32 v31, v113, v217
    v_mul_f32 v35, v113, v221
    v_mul_f32 v32, v114, v218
    v_mul_f32 v36, v114, v222
    v_mfma_f32_32x32x16_bf16 v[152:167], v[22:25], v[188:191], v[152:167]
    v_mul_f32 v33, v115, v219
    v_mul_f32 v37, v115, v223
    v_fma_f32 v30, -v128, v220, v30
    v_fmac_f32 v34, v128, v216
    v_fma_f32 v31, -v129, v221, v31
    v_fmac_f32 v35, v129, v217
    v_fma_f32 v32, -v130, v222, v32
    v_fmac_f32 v36, v130, v218
    v_fma_f32 v33, -v131, v223, v33
    v_fmac_f32 v37, v131, v219
    v_cvt_pk_bf16_f32 v42, v30, v32
    v_cvt_pk_bf16_f32 v50, v31, v33
    s_waitcnt lgkmcnt(0)
    v_mfma_f32_32x32x16_bf16 v[136:151], v[26:29], v[192:195], v[136:151]
    v_cvt_pk_bf16_f32 v46, v34, v36
    v_cvt_pk_bf16_f32 v54, v35, v37
    v_mul_f32 v30, v116, v224
    v_mul_f32 v34, v116, v228
    v_mul_f32 v31, v117, v225
    v_mul_f32 v35, v117, v229
    v_mul_f32 v32, v118, v226
    v_mul_f32 v36, v118, v230
    v_mul_f32 v33, v119, v227
    v_mul_f32 v37, v119, v231
    v_fma_f32 v30, -v132, v228, v30
    v_mfma_f32_32x32x16_bf16 v[152:167], v[26:29], v[196:199], v[152:167]
    v_fmac_f32 v34, v132, v224
    v_fma_f32 v31, -v133, v229, v31
    v_fmac_f32 v35, v133, v225
    v_fma_f32 v32, -v134, v230, v32
    v_fmac_f32 v36, v134, v226
    v_fma_f32 v33, -v135, v231, v33
    v_fmac_f32 v37, v135, v227
    v_cvt_pk_bf16_f32 v43, v30, v32
    v_cvt_pk_bf16_f32 v51, v31, v33
    v_cvt_pk_bf16_f32 v47, v34, v36
    v_cvt_pk_bf16_f32 v55, v35, v37
    v_mfma_f32_32x32x16_bf16 v[168:183], v[232:235], v[40:43], 0
    v_mul_f32 v30, v136, v72
    v_mul_f32 v34, v136, v76
    v_mul_f32 v31, v137, v73
    v_mul_f32 v35, v137, v77
    v_mul_f32 v32, v138, v74
    v_mul_f32 v36, v138, v78
    v_mul_f32 v33, v139, v75
    v_mul_f32 v37, v139, v79
    v_fma_f32 v30, -v152, v76, v30
    v_fmac_f32 v34, v152, v72
    v_mfma_f32_32x32x16_bf16 v[184:199], v[236:239], v[40:43], 0
    v_fma_f32 v31, -v153, v77, v31
    v_fmac_f32 v35, v153, v73
    v_fma_f32 v32, -v154, v78, v32
    v_fmac_f32 v36, v154, v74
    v_fma_f32 v33, -v155, v79, v33
    v_fmac_f32 v37, v155, v75
    v_cvt_pk_bf16_f32 v56, v30, v32
    v_cvt_pk_bf16_f32 v64, v31, v33
    v_cvt_pk_bf16_f32 v60, v34, v36
    v_cvt_pk_bf16_f32 v68, v35, v37
    v_mfma_f32_32x32x16_bf16 v[168:183], v[240:243], v[44:47], v[168:183]
    v_mul_f32 v30, v140, v80
    v_mul_f32 v34, v140, v84
    v_mul_f32 v31, v141, v81
    v_mul_f32 v35, v141, v85
    v_mul_f32 v32, v142, v82
    v_mul_f32 v36, v142, v86
    v_mul_f32 v33, v143, v83
    v_mul_f32 v37, v143, v87
    v_fma_f32 v30, -v156, v84, v30
    v_fmac_f32 v34, v156, v80
    v_mfma_f32_32x32x16_bf16 v[184:199], v[232:235], v[44:47], v[184:199]
    v_fma_f32 v31, -v157, v85, v31
    v_fmac_f32 v35, v157, v81
    v_fma_f32 v32, -v158, v86, v32
    v_fmac_f32 v36, v158, v82
    v_fma_f32 v33, -v159, v87, v33
    v_fmac_f32 v37, v159, v83
    v_cvt_pk_bf16_f32 v57, v30, v32
    v_cvt_pk_bf16_f32 v65, v31, v33
    v_cvt_pk_bf16_f32 v61, v34, v36
    v_cvt_pk_bf16_f32 v69, v35, v37
    v_mfma_f32_32x32x16_bf16 v[200:215], v[244:247], v[48:51], 0
    v_mul_f32 v30, v144, v88
    v_mul_f32 v34, v144, v92
    v_mul_f32 v31, v145, v89
    v_mul_f32 v35, v145, v93
    v_mul_f32 v32, v146, v90
    v_mul_f32 v36, v146, v94
    v_mul_f32 v33, v147, v91
    v_mul_f32 v37, v147, v95
    v_fma_f32 v30, -v160, v92, v30
    v_fmac_f32 v34, v160, v88
    v_mfma_f32_32x32x16_bf16 v[216:231], v[248:251], v[48:51], 0
    v_fma_f32 v31, -v161, v93, v31
    v_fmac_f32 v35, v161, v89
    v_fma_f32 v32, -v162, v94, v32
    v_fmac_f32 v36, v162, v90
    v_fma_f32 v33, -v163, v95, v33
    v_fmac_f32 v37, v163, v91
    v_cvt_pk_bf16_f32 v58, v30, v32
    v_cvt_pk_bf16_f32 v66, v31, v33
    v_cvt_pk_bf16_f32 v62, v34, v36
    v_cvt_pk_bf16_f32 v70, v35, v37
    v_mfma_f32_32x32x16_bf16 v[200:215], v[252:255], v[52:55], v[200:215]
    v_mul_f32 v30, v148, v96
    v_mul_f32 v34, v148, v100
    v_mul_f32 v31, v149, v97
    v_mul_f32 v35, v149, v101
    v_mul_f32 v32, v150, v98
    v_mul_f32 v36, v150, v102
    v_mul_f32 v33, v151, v99
    v_mul_f32 v37, v151, v103
    v_fma_f32 v30, -v164, v100, v30
    v_fmac_f32 v34, v164, v96
    v_mfma_f32_32x32x16_bf16 v[216:231], v[244:247], v[52:55], v[216:231]
    v_fma_f32 v31, -v165, v101, v31
    v_fmac_f32 v35, v165, v97
    v_fma_f32 v32, -v166, v102, v32
    v_fmac_f32 v36, v166, v98
    v_fma_f32 v33, -v167, v103, v33
    v_fmac_f32 v37, v167, v99
    v_cvt_pk_bf16_f32 v59, v30, v32
    v_cvt_pk_bf16_f32 v67, v31, v33
    v_cvt_pk_bf16_f32 v63, v34, v36
    v_cvt_pk_bf16_f32 v71, v35, v37
    ds_read_b128 v[232:235], v9 offset:3072
    ds_read_b128 v[236:239], v9 offset:4096
    ds_read_b128 v[240:243], v9 offset:5120
    ds_read_b128 v[244:247], v9 offset:9216
    ds_read_b128 v[248:251], v9 offset:10240
    ds_read_b128 v[252:255], v9 offset:11264
    s_mov_b32 s43, 7864320
    buffer_load_dwordx4 v[104:107], v8, s[16:19], s43 offen sc1
    s_mov_b32 s43, 7872512
    buffer_load_dwordx4 v[108:111], v8, s[16:19], s43 offen sc1
    s_mov_b32 s43, 7880704
    buffer_load_dwordx4 v[112:115], v8, s[16:19], s43 offen sc1
    s_mov_b32 s43, 7888896
    buffer_load_dwordx4 v[116:119], v8, s[16:19], s43 offen sc1
    s_waitcnt vmcnt(0)
    s_barrier
    s_waitcnt lgkmcnt(3)
    v_mfma_f32_32x32x16_bf16 v[168:183], v[232:235], v[56:59], v[168:183]
    ds_read2st64_b32 v[72:73], v11 offset0:0 offset1:1
    ds_read2st64_b32 v[74:75], v11 offset0:2 offset1:3
    v_mfma_f32_32x32x16_bf16 v[184:199], v[236:239], v[56:59], v[184:199]
    ds_read2st64_b32 v[76:77], v11 offset0:8 offset1:9
    ds_read2st64_b32 v[78:79], v11 offset0:10 offset1:11
    v_mfma_f32_32x32x16_bf16 v[168:183], v[240:243], v[60:63], v[168:183]
    ds_read2st64_b32 v[80:81], v11 offset0:16 offset1:17
    ds_read2st64_b32 v[82:83], v11 offset0:18 offset1:19
    v_mfma_f32_32x32x16_bf16 v[184:199], v[232:235], v[60:63], v[184:199]
    ds_read2st64_b32 v[84:85], v11 offset0:24 offset1:25
    ds_read2st64_b32 v[86:87], v11 offset0:26 offset1:27
    s_waitcnt lgkmcnt(8)
    v_mfma_f32_32x32x16_bf16 v[200:215], v[244:247], v[64:67], v[200:215]
    ds_read2st64_b32 v[88:89], v11 offset0:32 offset1:33
    ds_read2st64_b32 v[90:91], v11 offset0:34 offset1:35
    v_mfma_f32_32x32x16_bf16 v[216:231], v[248:251], v[64:67], v[216:231]
    ds_read2st64_b32 v[92:93], v11 offset0:40 offset1:41
    ds_read2st64_b32 v[94:95], v11 offset0:42 offset1:43
    v_mfma_f32_32x32x16_bf16 v[200:215], v[252:255], v[68:71], v[200:215]
    ds_read2st64_b32 v[96:97], v11 offset0:48 offset1:49
    ds_read2st64_b32 v[98:99], v11 offset0:50 offset1:51
    v_mfma_f32_32x32x16_bf16 v[216:231], v[244:247], v[68:71], v[216:231]
    ds_read2st64_b32 v[100:101], v11 offset0:56 offset1:57
    ds_read2st64_b32 v[102:103], v11 offset0:58 offset1:59
    ds_read_b128 v[232:235], v9 offset:0
    ds_read_b128 v[236:239], v9 offset:1024
    ds_read_b128 v[240:243], v9 offset:2048
    ds_read_b128 v[244:247], v9 offset:6144
    ds_read_b128 v[248:251], v9 offset:7168
    ds_read_b128 v[252:255], v9 offset:8192
    s_nop 0
    v_pk_add_f32 v[136:137], v[168:169], v[200:201]
    v_pk_add_f32 v[200:201], v[168:169], v[200:201] neg_lo:[0,1] neg_hi:[0,1]
    s_nop 0
    v_pk_add_f32 v[152:153], v[184:185], v[216:217]
    v_pk_add_f32 v[216:217], v[184:185], v[216:217] neg_lo:[0,1] neg_hi:[0,1]
    v_pk_add_f32 v[138:139], v[170:171], v[202:203]
    v_pk_add_f32 v[202:203], v[170:171], v[202:203] neg_lo:[0,1] neg_hi:[0,1]
    v_pk_add_f32 v[154:155], v[186:187], v[218:219]
    v_pk_add_f32 v[218:219], v[186:187], v[218:219] neg_lo:[0,1] neg_hi:[0,1]
    v_pk_add_f32 v[140:141], v[172:173], v[204:205]
    v_pk_add_f32 v[204:205], v[172:173], v[204:205] neg_lo:[0,1] neg_hi:[0,1]
    v_pk_add_f32 v[156:157], v[188:189], v[220:221]
    v_pk_add_f32 v[220:221], v[188:189], v[220:221] neg_lo:[0,1] neg_hi:[0,1]
    v_pk_add_f32 v[142:143], v[174:175], v[206:207]
    v_pk_add_f32 v[206:207], v[174:175], v[206:207] neg_lo:[0,1] neg_hi:[0,1]
    v_pk_add_f32 v[158:159], v[190:191], v[222:223]
    v_pk_add_f32 v[222:223], v[190:191], v[222:223] neg_lo:[0,1] neg_hi:[0,1]
    v_pk_add_f32 v[144:145], v[176:177], v[208:209]
    v_pk_add_f32 v[208:209], v[176:177], v[208:209] neg_lo:[0,1] neg_hi:[0,1]
    v_pk_add_f32 v[160:161], v[192:193], v[224:225]
    v_pk_add_f32 v[224:225], v[192:193], v[224:225] neg_lo:[0,1] neg_hi:[0,1]
    v_pk_add_f32 v[146:147], v[178:179], v[210:211]
    v_pk_add_f32 v[210:211], v[178:179], v[210:211] neg_lo:[0,1] neg_hi:[0,1]
    v_pk_add_f32 v[162:163], v[194:195], v[226:227]
    v_pk_add_f32 v[226:227], v[194:195], v[226:227] neg_lo:[0,1] neg_hi:[0,1]
    v_pk_add_f32 v[148:149], v[180:181], v[212:213]
    v_pk_add_f32 v[212:213], v[180:181], v[212:213] neg_lo:[0,1] neg_hi:[0,1]
    v_pk_add_f32 v[164:165], v[196:197], v[228:229]
    v_pk_add_f32 v[228:229], v[196:197], v[228:229] neg_lo:[0,1] neg_hi:[0,1]
    v_pk_add_f32 v[150:151], v[182:183], v[214:215]
    v_pk_add_f32 v[214:215], v[182:183], v[214:215] neg_lo:[0,1] neg_hi:[0,1]
    v_pk_add_f32 v[166:167], v[198:199], v[230:231]
    v_pk_add_f32 v[230:231], v[198:199], v[230:231] neg_lo:[0,1] neg_hi:[0,1]
    s_waitcnt lgkmcnt(6)
    s_cmp_eq_u32 s35, 0
    s_cbranch_scc0 K_nospecial
    v_and_b32 v168, 31, v1
    v_lshrrev_b32 v169, 5, v1
    s_cmp_eq_u32 s3, 0
    s_cbranch_scc0 K_sp_a
    v_lshl_add_u32 v174, v169, 7, v168
    v_lshlrev_b32 v170, 3, v174
    v_mov_b32 v172, v136
    v_mov_b32 v173, v152
    ds_write_b64 v170, v[172:173] offset:0
    v_mov_b32 v172, v137
    v_mov_b32 v173, v153
    ds_write_b64 v170, v[172:173] offset:256
    v_mov_b32 v172, v138
    v_mov_b32 v173, v154
    ds_write_b64 v170, v[172:173] offset:512
    v_mov_b32 v172, v139
    v_mov_b32 v173, v155
    ds_write_b64 v170, v[172:173] offset:768
    v_mov_b32 v172, v140
    v_mov_b32 v173, v156
    ds_write_b64 v170, v[172:173] offset:2048
    v_mov_b32 v172, v141
    v_mov_b32 v173, v157
    ds_write_b64 v170, v[172:173] offset:2304
    v_mov_b32 v172, v142
    v_mov_b32 v173, v158
    ds_write_b64 v170, v[172:173] offset:2560
    v_mov_b32 v172, v143
    v_mov_b32 v173, v159
    ds_write_b64 v170, v[172:173] offset:2816
    v_mov_b32 v172, v144
    v_mov_b32 v173, v160
    ds_write_b64 v170, v[172:173] offset:4096
    v_mov_b32 v172, v145
    v_mov_b32 v173, v161
    ds_write_b64 v170, v[172:173] offset:4352
    v_mov_b32 v172, v146
    v_mov_b32 v173, v162
    ds_write_b64 v170, v[172:173] offset:4608
    v_mov_b32 v172, v147
    v_mov_b32 v173, v163
    ds_write_b64 v170, v[172:173] offset:4864
    v_mov_b32 v172, v148
    v_mov_b32 v173, v164
    ds_write_b64 v170, v[172:173] offset:6144
    v_mov_b32 v172, v149
    v_mov_b32 v173, v165
    ds_write_b64 v170, v[172:173] offset:6400
    v_mov_b32 v172, v150
    v_mov_b32 v173, v166
    ds_write_b64 v170, v[172:173] offset:6656
    v_mov_b32 v172, v151
    v_mov_b32 v173, v167
    ds_write_b64 v170, v[172:173] offset:6912
    v_mov_b32 v172, v200
    v_mov_b32 v173, v216
    ds_write_b64 v170, v[172:173] offset:8192
    v_mov_b32 v172, v201
    v_mov_b32 v173, v217
    ds_write_b64 v170, v[172:173] offset:8448
    v_mov_b32 v172, v202
    v_mov_b32 v173, v218
    ds_write_b64 v170, v[172:173] offset:8704
    v_mov_b32 v172, v203
    v_mov_b32 v173, v219
    ds_write_b64 v170, v[172:173] offset:8960
    v_mov_b32 v172, v204
    v_mov_b32 v173, v220
    ds_write_b64 v170, v[172:173] offset:10240
    v_mov_b32 v172, v205
    v_mov_b32 v173, v221
    ds_write_b64 v170, v[172:173] offset:10496
    v_mov_b32 v172, v206
    v_mov_b32 v173, v222
    ds_write_b64 v170, v[172:173] offset:10752
    v_mov_b32 v172, v207
    v_mov_b32 v173, v223
    ds_write_b64 v170, v[172:173] offset:11008
    v_mov_b32 v172, v208
    v_mov_b32 v173, v224
    ds_write_b64 v170, v[172:173] offset:12288
    v_mov_b32 v172, v209
    v_mov_b32 v173, v225
    ds_write_b64 v170, v[172:173] offset:12544
    v_mov_b32 v172, v210
    v_mov_b32 v173, v226
    ds_write_b64 v170, v[172:173] offset:12800
    v_mov_b32 v172, v211
    v_mov_b32 v173, v227
    ds_write_b64 v170, v[172:173] offset:13056
    v_mov_b32 v172, v212
    v_mov_b32 v173, v228
    ds_write_b64 v170, v[172:173] offset:14336
    v_mov_b32 v172, v213
    v_mov_b32 v173, v229
    ds_write_b64 v170, v[172:173] offset:14592
    v_mov_b32 v172, v214
    v_mov_b32 v173, v230
    ds_write_b64 v170, v[172:173] offset:14848
    v_mov_b32 v172, v215
    v_mov_b32 v173, v231
    ds_write_b64 v170, v[172:173] offset:15104
    s_mov_b64 s[50:51], exec
    s_mov_b64 exec, 1
    v_mov_b32 v172, v136
    v_mov_b32 v173, v152
    v_mov_b32 v175, 16384
    ds_write_b64 v175, v[172:173]
    s_mov_b64 exec, s[50:51]
    s_waitcnt lgkmcnt(0)
K_sp_a:
    s_barrier
    v_lshlrev_b32 v192, 3, v0
    v_sub_u32 v193, 512, v0
    v_lshlrev_b32 v193, 3, v193
    ds_read_b64 v[176:177], v192 offset:0
    ds_read_b64 v[184:185], v193 offset:12288
    ds_read_b64 v[178:179], v192 offset:4096
    ds_read_b64 v[186:187], v193 offset:8192
    ds_read_b64 v[180:181], v192 offset:8192
    ds_read_b64 v[188:189], v193 offset:4096
    ds_read_b64 v[182:183], v192 offset:12288
    ds_read_b64 v[190:191], v193 offset:0
    s_waitcnt vmcnt(0) lgkmcnt(0)
    s_barrier
    v_mul_f32 v194, v176, v104
    v_mul_f32 v195, v176, v105
    v_fma_f32 v194, -v177, v105, v194
    v_fmac_f32 v195, v177, v104
    v_fmac_f32 v194, v184, v106
    v_fmac_f32 v195, v184, v107
    v_fmac_f32 v194, v185, v107
    v_fma_f32 v195, -v185, v106, v195
    ds_write_b64 v192, v[194:195] offset:0
    v_mul_f32 v194, v178, v108
    v_mul_f32 v195, v178, v109
    v_fma_f32 v194, -v179, v109, v194
    v_fmac_f32 v195, v179, v108
    v_fmac_f32 v194, v186, v110
    v_fmac_f32 v195, v186, v111
    v_fmac_f32 v194, v187, v111
    v_fma_f32 v195, -v187, v110, v195
    ds_write_b64 v192, v[194:195] offset:4096
    v_mul_f32 v194, v180, v112
    v_mul_f32 v195, v180, v113
    v_fma_f32 v194, -v181, v113, v194
    v_fmac_f32 v195, v181, v112
    v_fmac_f32 v194, v188, v114
    v_fmac_f32 v195, v188, v115
    v_fmac_f32 v194, v189, v115
    v_fma_f32 v195, -v189, v114, v195
    ds_write_b64 v192, v[194:195] offset:8192
    v_mul_f32 v194, v182, v116
    v_mul_f32 v195, v182, v117
    v_fma_f32 v194, -v183, v117, v194
    v_fmac_f32 v195, v183, v116
    v_fmac_f32 v194, v190, v118
    v_fmac_f32 v195, v190, v119
    v_fmac_f32 v194, v191, v119
    v_fma_f32 v195, -v191, v118, v195
    ds_write_b64 v192, v[194:195] offset:12288
    s_waitcnt lgkmcnt(0)
    s_barrier
    s_cmp_eq_u32 s3, 0
    s_cbranch_scc0 K_sp_b
    ds_read_b32 v136, v170 offset:0
    ds_read_b32 v152, v170 offset:4
    ds_read_b32 v137, v170 offset:256
    ds_read_b32 v153, v170 offset:260
    ds_read_b32 v138, v170 offset:512
    ds_read_b32 v154, v170 offset:516
    ds_read_b32 v139, v170 offset:768
    ds_read_b32 v155, v170 offset:772
    ds_read_b32 v140, v170 offset:2048
    ds_read_b32 v156, v170 offset:2052
    ds_read_b32 v141, v170 offset:2304
    ds_read_b32 v157, v170 offset:2308
    ds_read_b32 v142, v170 offset:2560
    ds_read_b32 v158, v170 offset:2564
    ds_read_b32 v143, v170 offset:2816
    ds_read_b32 v159, v170 offset:2820
    ds_read_b32 v144, v170 offset:4096
    ds_read_b32 v160, v170 offset:4100
    ds_read_b32 v145, v170 offset:4352
    ds_read_b32 v161, v170 offset:4356
    ds_read_b32 v146, v170 offset:4608
    ds_read_b32 v162, v170 offset:4612
    ds_read_b32 v147, v170 offset:4864
    ds_read_b32 v163, v170 offset:4868
    ds_read_b32 v148, v170 offset:6144
    ds_read_b32 v164, v170 offset:6148
    ds_read_b32 v149, v170 offset:6400
    ds_read_b32 v165, v170 offset:6404
    ds_read_b32 v150, v170 offset:6656
    ds_read_b32 v166, v170 offset:6660
    ds_read_b32 v151, v170 offset:6912
    ds_read_b32 v167, v170 offset:6916
    ds_read_b32 v200, v170 offset:8192
    ds_read_b32 v216, v170 offset:8196
    ds_read_b32 v201, v170 offset:8448
    ds_read_b32 v217, v170 offset:8452
    ds_read_b32 v202, v170 offset:8704
    ds_read_b32 v218, v170 offset:8708
    ds_read_b32 v203, v170 offset:8960
    ds_read_b32 v219, v170 offset:8964
    ds_read_b32 v204, v170 offset:10240
    ds_read_b32 v220, v170 offset:10244
    ds_read_b32 v205, v170 offset:10496
    ds_read_b32 v221, v170 offset:10500
    ds_read_b32 v206, v170 offset:10752
    ds_read_b32 v222, v170 offset:10756
    ds_read_b32 v207, v170 offset:11008
    ds_read_b32 v223, v170 offset:11012
    ds_read_b32 v208, v170 offset:12288
    ds_read_b32 v224, v170 offset:12292
    ds_read_b32 v209, v170 offset:12544
    ds_read_b32 v225, v170 offset:12548
    ds_read_b32 v210, v170 offset:12800
    ds_read_b32 v226, v170 offset:12804
    ds_read_b32 v211, v170 offset:13056
    ds_read_b32 v227, v170 offset:13060
    ds_read_b32 v212, v170 offset:14336
    ds_read_b32 v228, v170 offset:14340
    ds_read_b32 v213, v170 offset:14592
    ds_read_b32 v229, v170 offset:14596
    ds_read_b32 v214, v170 offset:14848
    ds_read_b32 v230, v170 offset:14852
    ds_read_b32 v215, v170 offset:15104
    ds_read_b32 v231, v170 offset:15108
    v_mov_b32 v72, 0x00003f80
    v_mov_b32 v73, 0x00003f80
    v_mov_b32 v74, 0x00003f80
    v_mov_b32 v75, 0x00003f80
    v_mov_b32 v76, 0x00003f80
    v_mov_b32 v77, 0x00003f80
    v_mov_b32 v78, 0x00003f80
    v_mov_b32 v79, 0x00003f80
    v_mov_b32 v80, 0x00003f80
    v_mov_b32 v81, 0x00003f80
    v_mov_b32 v82, 0x00003f80
    v_mov_b32 v83, 0x00003f80
    v_mov_b32 v84, 0x00003f80
    v_mov_b32 v85, 0x00003f80
    v_mov_b32 v86, 0x00003f80
    v_mov_b32 v87, 0x00003f80
    v_mov_b32 v88, 0x00003f80
    v_mov_b32 v89, 0x00003f80
    v_mov_b32 v90, 0x00003f80
    v_mov_b32 v91, 0x00003f80
    v_mov_b32 v92, 0x00003f80
    v_mov_b32 v93, 0x00003f80
    v_mov_b32 v94, 0x00003f80
    v_mov_b32 v95, 0x00003f80
    v_mov_b32 v96, 0x00003f80
    v_mov_b32 v97, 0x00003f80
    v_mov_b32 v98, 0x00003f80
    v_mov_b32 v99, 0x00003f80
    v_mov_b32 v100, 0x00003f80
    v_mov_b32 v101, 0x00003f80
    v_mov_b32 v102, 0x00003f80
    v_mov_b32 v103, 0x00003f80
    s_waitcnt lgkmcnt(0)
K_sp_b:
    s_barrier
K_nospecial:
    v_lshlrev_b32 v14, 16, v72
    v_and_b32 v18, 0xffff0000, v72
    v_lshlrev_b32 v15, 16, v73
    v_and_b32 v19, 0xffff0000, v73
    v_lshlrev_b32 v16, 16, v74
    v_and_b32 v20, 0xffff0000, v74
    v_lshlrev_b32 v17, 16, v75
    v_and_b32 v21, 0xffff0000, v75
    v_pk_mul_f32 v[30:31], v[136:137], v[14:15]
    v_pk_mul_f32 v[34:35], v[136:137], v[18:19]
    v_pk_mul_f32 v[32:33], v[138:139], v[16:17]
    v_pk_mul_f32 v[36:37], v[138:139], v[20:21]
    v_pk_fma_f32 v[30:31], v[152:153], v[18:19], v[30:31] neg_lo:[1,0,0] neg_hi:[1,0,0]
    v_pk_fma_f32 v[34:35], v[152:153], v[14:15], v[34:35]
    v_pk_fma_f32 v[32:33], v[154:155], v[20:21], v[32:33] neg_lo:[1,0,0] neg_hi:[1,0,0]
    v_pk_fma_f32 v[36:37], v[154:155], v[16:17], v[36:37]
    v_cvt_pk_bf16_f32 v40, v30, v32
    v_cvt_pk_bf16_f32 v48, v31, v33
    v_cvt_pk_bf16_f32 v44, v34, v36
    v_cvt_pk_bf16_f32 v52, v35, v37
    v_lshlrev_b32 v14, 16, v76
    v_and_b32 v18, 0xffff0000, v76
    v_lshlrev_b32 v15, 16, v77
    v_and_b32 v19, 0xffff0000, v77
    v_lshlrev_b32 v16, 16, v78
    v_and_b32 v20, 0xffff0000, v78
    v_lshlrev_b32 v17, 16, v79
    v_and_b32 v21, 0xffff0000, v79
    v_pk_mul_f32 v[30:31], v[140:141], v[14:15]
    v_pk_mul_f32 v[34:35], v[140:141], v[18:19]
    v_pk_mul_f32 v[32:33], v[142:143], v[16:17]
    v_pk_mul_f32 v[36:37], v[142:143], v[20:21]
    v_pk_fma_f32 v[30:31], v[156:157], v[18:19], v[30:31] neg_lo:[1,0,0] neg_hi:[1,0,0]
    v_pk_fma_f32 v[34:35], v[156:157], v[14:15], v[34:35]
    v_pk_fma_f32 v[32:33], v[158:159], v[20:21], v[32:33] neg_lo:[1,0,0] neg_hi:[1,0,0]
    v_pk_fma_f32 v[36:37], v[158:159], v[16:17], v[36:37]
    v_cvt_pk_bf16_f32 v41, v30, v32
    v_cvt_pk_bf16_f32 v49, v31, v33
    v_cvt_pk_bf16_f32 v45, v34, v36
    v_cvt_pk_bf16_f32 v53, v35, v37
    v_lshlrev_b32 v14, 16, v80
    v_and_b32 v18, 0xffff0000, v80
    v_lshlrev_b32 v15, 16, v81
    v_and_b32 v19, 0xffff0000, v81
    v_lshlrev_b32 v16, 16, v82
    v_and_b32 v20, 0xffff0000, v82
    v_lshlrev_b32 v17, 16, v83
    v_and_b32 v21, 0xffff0000, v83
    v_pk_mul_f32 v[30:31], v[144:145], v[14:15]
    v_pk_mul_f32 v[34:35], v[144:145], v[18:19]
    v_pk_mul_f32 v[32:33], v[146:147], v[16:17]
    v_pk_mul_f32 v[36:37], v[146:147], v[20:21]
    v_pk_fma_f32 v[30:31], v[160:161], v[18:19], v[30:31] neg_lo:[1,0,0] neg_hi:[1,0,0]
    v_pk_fma_f32 v[34:35], v[160:161], v[14:15], v[34:35]
    v_pk_fma_f32 v[32:33], v[162:163], v[20:21], v[32:33] neg_lo:[1,0,0] neg_hi:[1,0,0]
    v_pk_fma_f32 v[36:37], v[162:163], v[16:17], v[36:37]
    v_cvt_pk_bf16_f32 v42, v30, v32
    v_cvt_pk_bf16_f32 v50, v31, v33
    v_cvt_pk_bf16_f32 v46, v34, v36
    v_cvt_pk_bf16_f32 v54, v35, v37
    v_lshlrev_b32 v14, 16, v84
    v_and_b32 v18, 0xffff0000, v84
    v_lshlrev_b32 v15, 16, v85
    v_and_b32 v19, 0xffff0000, v85
    v_lshlrev_b32 v16, 16, v86
    v_and_b32 v20, 0xffff0000, v86
    v_lshlrev_b32 v17, 16, v87
    v_and_b32 v21, 0xffff0000, v87
    v_pk_mul_f32 v[30:31], v[148:149], v[14:15]
    v_pk_mul_f32 v[34:35], v[148:149], v[18:19]
    v_pk_mul_f32 v[32:33], v[150:151], v[16:17]
    v_pk_mul_f32 v[36:37], v[150:151], v[20:21]
    v_pk_fma_f32 v[30:31], v[164:165], v[18:19], v[30:31] neg_lo:[1,0,0] neg_hi:[1,0,0]
    v_pk_fma_f32 v[34:35], v[164:165], v[14:15], v[34:35]
    v_pk_fma_f32 v[32:33], v[166:167], v[20:21], v[32:33] neg_lo:[1,0,0] neg_hi:[1,0,0]
    v_pk_fma_f32 v[36:37], v[166:167], v[16:17], v[36:37]
    v_cvt_pk_bf16_f32 v43, v30, v32
    v_cvt_pk_bf16_f32 v51, v31, v33
    v_cvt_pk_bf16_f32 v47, v34, v36
    v_cvt_pk_bf16_f32 v55, v35, v37
    s_waitcnt lgkmcnt(3)
    v_mfma_f32_32x32x16_bf16 v[104:119], v[40:43], v[232:235], 0
    v_lshlrev_b32 v14, 16, v88
    v_and_b32 v18, 0xffff0000, v88
    v_lshlrev_b32 v15, 16, v89
    v_and_b32 v19, 0xffff0000, v89
    v_lshlrev_b32 v16, 16, v90
    v_and_b32 v20, 0xffff0000, v90
    v_lshlrev_b32 v17, 16, v91
    v_and_b32 v21, 0xffff0000, v91
    v_mul_f32 v30, v200, v14
    v_mul_f32 v34, v200, v18
    v_mul_f32 v31, v201, v15
    v_mul_f32 v35, v201, v19
    v_mul_f32 v32, v202, v16
    v_mul_f32 v36, v202, v20
    v_mfma_f32_32x32x16_bf16 v[120:135], v[44:47], v[232:235], 0
    v_mul_f32 v33, v203, v17
    v_mul_f32 v37, v203, v21
    v_fma_f32 v30, -v216, v18, v30
    v_fmac_f32 v34, v216, v14
    v_fma_f32 v31, -v217, v19, v31
    v_fmac_f32 v35, v217, v15
    v_fma_f32 v32, -v218, v20, v32
    v_fmac_f32 v36, v218, v16
    v_fma_f32 v33, -v219, v21, v33
    v_fmac_f32 v37, v219, v17
    v_cvt_pk_bf16_f32 v56, v30, v32
    v_cvt_pk_bf16_f32 v64, v31, v33
    v_cvt_pk_bf16_f32 v60, v34, v36
    v_cvt_pk_bf16_f32 v68, v35, v37
    v_mfma_f32_32x32x16_bf16 v[104:119], v[44:47], v[236:239], v[104:119]
    v_lshlrev_b32 v14, 16, v92
    v_and_b32 v18, 0xffff0000, v92
    v_lshlrev_b32 v15, 16, v93
    v_and_b32 v19, 0xffff0000, v93
    v_lshlrev_b32 v16, 16, v94
    v_and_b32 v20, 0xffff0000, v94
    v_lshlrev_b32 v17, 16, v95
    v_and_b32 v21, 0xffff0000, v95
    v_mul_f32 v30, v204, v14
    v_mul_f32 v34, v204, v18
    v_mul_f32 v31, v205, v15
    v_mul_f32 v35, v205, v19
    v_mul_f32 v32, v206, v16
    v_mul_f32 v36, v206, v20
    v_mfma_f32_32x32x16_bf16 v[120:135], v[40:43], v[240:243], v[120:135]
    v_mul_f32 v33, v207, v17
    v_mul_f32 v37, v207, v21
    v_fma_f32 v30, -v220, v18, v30
    v_fmac_f32 v34, v220, v14
    v_fma_f32 v31, -v221, v19, v31
    v_fmac_f32 v35, v221, v15
    v_fma_f32 v32, -v222, v20, v32
    v_fmac_f32 v36, v222, v16
    v_fma_f32 v33, -v223, v21, v33
    v_fmac_f32 v37, v223, v17
    v_cvt_pk_bf16_f32 v57, v30, v32
    v_cvt_pk_bf16_f32 v65, v31, v33
    v_cvt_pk_bf16_f32 v61, v34, v36
    v_cvt_pk_bf16_f32 v69, v35, v37
    s_waitcnt lgkmcnt(0)
    v_mfma_f32_32x32x16_bf16 v[136:151], v[48:51], v[244:247], 0
    v_lshlrev_b32 v14, 16, v96
    v_and_b32 v18, 0xffff0000, v96
    v_lshlrev_b32 v15, 16, v97
    v_and_b32 v19, 0xffff0000, v97
    v_lshlrev_b32 v16, 16, v98
    v_and_b32 v20, 0xffff0000, v98
    v_lshlrev_b32 v17, 16, v99
    v_and_b32 v21, 0xffff0000, v99
    v_mul_f32 v30, v208, v14
    v_mul_f32 v34, v208, v18
    v_mul_f32 v31, v209, v15
    v_mul_f32 v35, v209, v19
    v_mul_f32 v32, v210, v16
    v_mul_f32 v36, v210, v20
    v_mfma_f32_32x32x16_bf16 v[152:167], v[52:55], v[244:247], 0
    v_mul_f32 v33, v211, v17
    v_mul_f32 v37, v211, v21
    v_fma_f32 v30, -v224, v18, v30
    v_fmac_f32 v34, v224, v14
    v_fma_f32 v31, -v225, v19, v31
    v_fmac_f32 v35, v225, v15
    v_fma_f32 v32, -v226, v20, v32
    v_fmac_f32 v36, v226, v16
    v_fma_f32 v33, -v227, v21, v33
    v_fmac_f32 v37, v227, v17
    v_cvt_pk_bf16_f32 v58, v30, v32
    v_cvt_pk_bf16_f32 v66, v31, v33
    v_cvt_pk_bf16_f32 v62, v34, v36
    v_cvt_pk_bf16_f32 v70, v35, v37
    v_mfma_f32_32x32x16_bf16 v[136:151], v[52:55], v[248:251], v[136:151]
    v_lshlrev_b32 v14, 16, v100
    v_and_b32 v18, 0xffff0000, v100
    v_lshlrev_b32 v15, 16, v101
    v_and_b32 v19, 0xffff0000, v101
    v_lshlrev_b32 v16, 16, v102
    v_and_b32 v20, 0xffff0000, v102
    v_lshlrev_b32 v17, 16, v103
    v_and_b32 v21, 0xffff0000, v103
    v_mul_f32 v30, v212, v14
    v_mul_f32 v34, v212, v18
    v_mul_f32 v31, v213, v15
    v_mul_f32 v35, v213, v19
    v_mul_f32 v32, v214, v16
    v_mul_f32 v36, v214, v20
    v_mfma_f32_32x32x16_bf16 v[152:167], v[48:51], v[252:255], v[152:167]
    v_mul_f32 v33, v215, v17
    v_mul_f32 v37, v215, v21
    v_fma_f32 v30, -v228, v18, v30
    v_fmac_f32 v34, v228, v14
    v_fma_f32 v31, -v229, v19, v31
    v_fmac_f32 v35, v229, v15
    v_fma_f32 v32, -v230, v20, v32
    v_fmac_f32 v36, v230, v16
    v_fma_f32 v33, -v231, v21, v33
    v_fmac_f32 v37, v231, v17
    v_cvt_pk_bf16_f32 v59, v30, v32
    v_cvt_pk_bf16_f32 v67, v31, v33
    v_cvt_pk_bf16_f32 v63, v34, v36
    v_cvt_pk_bf16_f32 v71, v35, v37
    ds_read_b128 v[232:235], v9 offset:3072
    ds_read_b128 v[236:239], v9 offset:4096
    ds_read_b128 v[240:243], v9 offset:5120
    ds_read_b128 v[244:247], v9 offset:9216
    ds_read_b128 v[248:251], v9 offset:10240
    ds_read_b128 v[252:255], v9 offset:11264
    s_waitcnt lgkmcnt(3)
    v_mfma_f32_32x32x16_bf16 v[104:119], v[56:59], v[232:235], v[104:119]
    ds_read_b128 v[72:75], v9 offset:12288
    v_mfma_f32_32x32x16_bf16 v[120:135], v[60:63], v[232:235], v[120:135]
    ds_read_b128 v[76:79], v9 offset:13312
    v_mfma_f32_32x32x16_bf16 v[104:119], v[60:63], v[236:239], v[104:119]
    ds_read_b128 v[80:83], v9 offset:14336
    v_mfma_f32_32x32x16_bf16 v[120:135], v[56:59], v[240:243], v[120:135]
    s_waitcnt lgkmcnt(3)
    v_mfma_f32_32x32x16_bf16 v[136:151], v[64:67], v[244:247], v[136:151]
    ds_read_b128 v[84:87], v9 offset:15360
    v_mfma_f32_32x32x16_bf16 v[152:167], v[68:71], v[244:247], v[152:167]
    ds_read_b128 v[14:17], v9 offset:16384
    v_mfma_f32_32x32x16_bf16 v[136:151], v[68:71], v[248:251], v[136:151]
    ds_read_b128 v[18:21], v9 offset:17408
    v_mfma_f32_32x32x16_bf16 v[152:167], v[64:67], v[252:255], v[152:167]
    s_nop 9
    v_pk_add_f32 v[200:201], v[104:105], v[136:137]
    v_pk_add_f32 v[136:137], v[104:105], v[136:137] neg_lo:[0,1] neg_hi:[0,1]
    v_pk_add_f32 v[216:217], v[120:121], v[152:153]
    v_pk_add_f32 v[152:153], v[120:121], v[152:153] neg_lo:[0,1] neg_hi:[0,1]
    v_pk_add_f32 v[202:203], v[106:107], v[138:139]
    v_pk_add_f32 v[138:139], v[106:107], v[138:139] neg_lo:[0,1] neg_hi:[0,1]
    v_pk_add_f32 v[218:219], v[122:123], v[154:155]
    v_pk_add_f32 v[154:155], v[122:123], v[154:155] neg_lo:[0,1] neg_hi:[0,1]
    v_pk_add_f32 v[204:205], v[108:109], v[140:141]
    v_pk_add_f32 v[140:141], v[108:109], v[140:141] neg_lo:[0,1] neg_hi:[0,1]
    v_pk_add_f32 v[220:221], v[124:125], v[156:157]
    v_pk_add_f32 v[156:157], v[124:125], v[156:157] neg_lo:[0,1] neg_hi:[0,1]
    v_pk_add_f32 v[206:207], v[110:111], v[142:143]
    v_pk_add_f32 v[142:143], v[110:111], v[142:143] neg_lo:[0,1] neg_hi:[0,1]
    v_pk_add_f32 v[222:223], v[126:127], v[158:159]
    v_pk_add_f32 v[158:159], v[126:127], v[158:159] neg_lo:[0,1] neg_hi:[0,1]
    v_pk_add_f32 v[208:209], v[112:113], v[144:145]
    v_pk_add_f32 v[144:145], v[112:113], v[144:145] neg_lo:[0,1] neg_hi:[0,1]
    v_pk_add_f32 v[224:225], v[128:129], v[160:161]
    v_pk_add_f32 v[160:161], v[128:129], v[160:161] neg_lo:[0,1] neg_hi:[0,1]
    v_pk_add_f32 v[210:211], v[114:115], v[146:147]
    v_pk_add_f32 v[146:147], v[114:115], v[146:147] neg_lo:[0,1] neg_hi:[0,1]
    v_pk_add_f32 v[226:227], v[130:131], v[162:163]
    v_pk_add_f32 v[162:163], v[130:131], v[162:163] neg_lo:[0,1] neg_hi:[0,1]
    v_pk_add_f32 v[212:213], v[116:117], v[148:149]
    v_pk_add_f32 v[148:149], v[116:117], v[148:149] neg_lo:[0,1] neg_hi:[0,1]
    v_pk_add_f32 v[228:229], v[132:133], v[164:165]
    v_pk_add_f32 v[164:165], v[132:133], v[164:165] neg_lo:[0,1] neg_hi:[0,1]
    v_pk_add_f32 v[214:215], v[118:119], v[150:151]
    v_pk_add_f32 v[150:151], v[118:119], v[150:151] neg_lo:[0,1] neg_hi:[0,1]
    v_pk_add_f32 v[230:231], v[134:135], v[166:167]
    v_pk_add_f32 v[166:167], v[134:135], v[166:167] neg_lo:[0,1] neg_hi:[0,1]
    s_waitcnt lgkmcnt(2)
    ds_read_b128 v[22:25], v9 offset:18432
    ds_read_b128 v[26:29], v9 offset:19456
    s_waitcnt lgkmcnt(2)
    v_pk_mul_f32 v[30:31], v[200:201], v[14:15]
    v_pk_mul_f32 v[34:35], v[200:201], v[18:19]
    v_pk_mul_f32 v[32:33], v[202:203], v[16:17]
    v_pk_mul_f32 v[36:37], v[202:203], v[20:21]
    v_pk_fma_f32 v[30:31], v[216:217], v[18:19], v[30:31] neg_lo:[1,0,0] neg_hi:[1,0,0]
    v_pk_fma_f32 v[34:35], v[216:217], v[14:15], v[34:35]
    v_pk_fma_f32 v[32:33], v[218:219], v[20:21], v[32:33] neg_lo:[1,0,0] neg_hi:[1,0,0]
    v_pk_fma_f32 v[36:37], v[218:219], v[16:17], v[36:37]
    v_cvt_pk_bf16_f32 v40, v30, v31
    v_cvt_pk_bf16_f32 v41, v32, v33
    v_cvt_pk_bf16_f32 v48, v34, v35
    v_cvt_pk_bf16_f32 v49, v36, v37
    v_cvt_pk_bf16_f32 v88, -v30, -v31
    v_cvt_pk_bf16_f32 v89, -v32, -v33
    ds_read_b128 v[14:17], v9 offset:20480
    ds_read_b128 v[18:21], v9 offset:21504
    s_waitcnt lgkmcnt(2)
    v_pk_mul_f32 v[30:31], v[204:205], v[22:23]
    v_pk_mul_f32 v[34:35], v[204:205], v[26:27]
    v_pk_mul_f32 v[32:33], v[206:207], v[24:25]
    v_pk_mul_f32 v[36:37], v[206:207], v[28:29]
    v_pk_fma_f32 v[30:31], v[220:221], v[26:27], v[30:31] neg_lo:[1,0,0] neg_hi:[1,0,0]
    v_pk_fma_f32 v[34:35], v[220:221], v[22:23], v[34:35]
    v_pk_fma_f32 v[32:33], v[222:223], v[28:29], v[32:33] neg_lo:[1,0,0] neg_hi:[1,0,0]
    v_pk_fma_f32 v[36:37], v[222:223], v[24:25], v[36:37]
    v_cvt_pk_bf16_f32 v42, v30, v31
    v_cvt_pk_bf16_f32 v43, v32, v33
    v_cvt_pk_bf16_f32 v50, v34, v35
    v_cvt_pk_bf16_f32 v51, v36, v37
    v_cvt_pk_bf16_f32 v90, -v30, -v31
    v_cvt_pk_bf16_f32 v91, -v32, -v33
    ds_read_b128 v[22:25], v9 offset:22528
    ds_read_b128 v[26:29], v9 offset:23552
    s_waitcnt lgkmcnt(2)
    v_pk_mul_f32 v[30:31], v[208:209], v[14:15]
    v_pk_mul_f32 v[34:35], v[208:209], v[18:19]
    v_pk_mul_f32 v[32:33], v[210:211], v[16:17]
    v_pk_mul_f32 v[36:37], v[210:211], v[20:21]
    v_pk_fma_f32 v[30:31], v[224:225], v[18:19], v[30:31] neg_lo:[1,0,0] neg_hi:[1,0,0]
    v_pk_fma_f32 v[34:35], v[224:225], v[14:15], v[34:35]
    v_pk_fma_f32 v[32:33], v[226:227], v[20:21], v[32:33] neg_lo:[1,0,0] neg_hi:[1,0,0]
    v_pk_fma_f32 v[36:37], v[226:227], v[16:17], v[36:37]
    v_cvt_pk_bf16_f32 v44, v30, v31
    v_cvt_pk_bf16_f32 v45, v32, v33
    v_cvt_pk_bf16_f32 v52, v34, v35
    v_cvt_pk_bf16_f32 v53, v36, v37
    v_cvt_pk_bf16_f32 v92, -v30, -v31
    v_cvt_pk_bf16_f32 v93, -v32, -v33
    s_waitcnt lgkmcnt(0)
    v_pk_mul_f32 v[30:31], v[212:213], v[22:23]
    v_pk_mul_f32 v[34:35], v[212:213], v[26:27]
    v_pk_mul_f32 v[32:33], v[214:215], v[24:25]
    v_pk_mul_f32 v[36:37], v[214:215], v[28:29]
    v_pk_fma_f32 v[30:31], v[228:229], v[26:27], v[30:31] neg_lo:[1,0,0] neg_hi:[1,0,0]
    v_pk_fma_f32 v[34:35], v[228:229], v[22:23], v[34:35]
    v_pk_fma_f32 v[32:33], v[230:231], v[28:29], v[32:33] neg_lo:[1,0,0] neg_hi:[1,0,0]
    v_pk_fma_f32 v[36:37], v[230:231], v[24:25], v[36:37]
    v_cvt_pk_bf16_f32 v46, v30, v31
    v_cvt_pk_bf16_f32 v47, v32, v33
    v_cvt_pk_bf16_f32 v54, v34, v35
    v_cvt_pk_bf16_f32 v55, v36, v37
    v_cvt_pk_bf16_f32 v94, -v30, -v31
    v_cvt_pk_bf16_f32 v95, -v32, -v33
    v_mfma_f32_32x32x16_bf16 v[168:183], v[72:75], v[40:43], 0
    ds_read_b128 v[14:17], v9 offset:24576
    ds_read_b128 v[18:21], v9 offset:25600
    ds_read_b128 v[22:25], v9 offset:26624
    ds_read_b128 v[26:29], v9 offset:27648
    s_waitcnt lgkmcnt(2)
    v_mul_f32 v30, v136, v14
    v_mul_f32 v34, v136, v18
    v_mul_f32 v31, v137, v15
    v_mul_f32 v35, v137, v19
    v_mul_f32 v32, v138, v16
    v_mul_f32 v36, v138, v20
    v_mul_f32 v33, v139, v17
    v_mul_f32 v37, v139, v21
    v_mfma_f32_32x32x16_bf16 v[184:199], v[72:75], v[48:51], 0
    v_fma_f32 v30, -v152, v18, v30
    v_fmac_f32 v34, v152, v14
    v_fma_f32 v31, -v153, v19, v31
    v_fmac_f32 v35, v153, v15
    v_fma_f32 v32, -v154, v20, v32
    v_fmac_f32 v36, v154, v16
    v_fma_f32 v33, -v155, v21, v33
    v_fmac_f32 v37, v155, v17
    v_cvt_pk_bf16_f32 v56, v30, v31
    v_cvt_pk_bf16_f32 v57, v32, v33
    v_cvt_pk_bf16_f32 v64, v34, v35
    v_cvt_pk_bf16_f32 v65, v36, v37
    v_mfma_f32_32x32x16_bf16 v[168:183], v[76:79], v[48:51], v[168:183]
    v_cvt_pk_bf16_f32 v96, -v30, -v31
    v_cvt_pk_bf16_f32 v97, -v32, -v33
    ds_read_b128 v[14:17], v9 offset:28672
    ds_read_b128 v[18:21], v9 offset:29696
    s_waitcnt lgkmcnt(2)
    v_mul_f32 v30, v140, v22
    v_mul_f32 v34, v140, v26
    v_mul_f32 v31, v141, v23
    v_mul_f32 v35, v141, v27
    v_mul_f32 v32, v142, v24
    v_mul_f32 v36, v142, v28
    v_mul_f32 v33, v143, v25
    v_mul_f32 v37, v143, v29
    v_mfma_f32_32x32x16_bf16 v[184:199], v[76:79], v[88:91], v[184:199]
    v_fma_f32 v30, -v156, v26, v30
    v_fmac_f32 v34, v156, v22
    v_fma_f32 v31, -v157, v27, v31
    v_fmac_f32 v35, v157, v23
    v_fma_f32 v32, -v158, v28, v32
    v_fmac_f32 v36, v158, v24
    v_fma_f32 v33, -v159, v29, v33
    v_fmac_f32 v37, v159, v25
    v_cvt_pk_bf16_f32 v58, v30, v31
    v_cvt_pk_bf16_f32 v59, v32, v33
    v_cvt_pk_bf16_f32 v66, v34, v35
    v_cvt_pk_bf16_f32 v67, v36, v37
    v_mfma_f32_32x32x16_bf16 v[168:183], v[80:83], v[44:47], v[168:183]
    v_cvt_pk_bf16_f32 v98, -v30, -v31
    v_cvt_pk_bf16_f32 v99, -v32, -v33
    ds_read_b128 v[22:25], v9 offset:30720
    ds_read_b128 v[26:29], v9 offset:31744
    s_waitcnt lgkmcnt(2)
    v_mul_f32 v30, v144, v14
    v_mul_f32 v34, v144, v18
    v_mul_f32 v31, v145, v15
    v_mul_f32 v35, v145, v19
    v_mul_f32 v32, v146, v16
    v_mul_f32 v36, v146, v20
    v_mul_f32 v33, v147, v17
    v_mul_f32 v37, v147, v21
    v_mfma_f32_32x32x16_bf16 v[184:199], v[80:83], v[52:55], v[184:199]
    v_fma_f32 v30, -v160, v18, v30
    v_fmac_f32 v34, v160, v14
    v_fma_f32 v31, -v161, v19, v31
    v_fmac_f32 v35, v161, v15
    v_fma_f32 v32, -v162, v20, v32
    v_fmac_f32 v36, v162, v16
    v_fma_f32 v33, -v163, v21, v33
    v_fmac_f32 v37, v163, v17
    v_cvt_pk_bf16_f32 v60, v30, v31
    v_cvt_pk_bf16_f32 v61, v32, v33
    v_cvt_pk_bf16_f32 v68, v34, v35
    v_cvt_pk_bf16_f32 v69, v36, v37
    v_mfma_f32_32x32x16_bf16 v[168:183], v[84:87], v[52:55], v[168:183]
    v_cvt_pk_bf16_f32 v100, -v30, -v31
    v_cvt_pk_bf16_f32 v101, -v32, -v33
    s_waitcnt lgkmcnt(0)
    v_mul_f32 v30, v148, v22
    v_mul_f32 v34, v148, v26
    v_mul_f32 v31, v149, v23
    v_mul_f32 v35, v149, v27
    v_mul_f32 v32, v150, v24
    v_mul_f32 v36, v150, v28
    v_mul_f32 v33, v151, v25
    v_mul_f32 v37, v151, v29
    v_fma_f32 v30, -v164, v26, v30
    v_fmac_f32 v34, v164, v22
    v_mfma_f32_32x32x16_bf16 v[184:199], v[84:87], v[92:95], v[184:199]
    v_fma_f32 v31, -v165, v27, v31
    v_fmac_f32 v35, v165, v23
    v_fma_f32 v32, -v166, v28, v32
    v_fmac_f32 v36, v166, v24
    v_fma_f32 v33, -v167, v29, v33
    v_fmac_f32 v37, v167, v25
    v_cvt_pk_bf16_f32 v62, v30, v31
    v_cvt_pk_bf16_f32 v63, v32, v33
    v_cvt_pk_bf16_f32 v70, v34, v35
    v_cvt_pk_bf16_f32 v71, v36, v37
    v_cvt_pk_bf16_f32 v102, -v30, -v31
    v_cvt_pk_bf16_f32 v103, -v32, -v33
    v_mfma_f32_32x32x16_bf16 v[200:215], v[72:75], v[56:59], 0
    v_mfma_f32_32x32x16_bf16 v[216:231], v[72:75], v[64:67], 0
    v_cvt_pk_bf16_f32 v30, v168, v184
    v_cvt_pk_bf16_f32 v31, v169, v185
    v_cvt_pk_bf16_f32 v32, v170, v186
    v_cvt_pk_bf16_f32 v33, v171, v187
    ds_write_b32 v12, v30 offset:0
    v_mfma_f32_32x32x16_bf16 v[200:215], v[76:79], v[64:67], v[200:215]
    ds_write_b32 v12, v31 offset:1024
    ds_write_b32 v12, v32 offset:2048
    ds_write_b32 v12, v33 offset:3072
    v_cvt_pk_bf16_f32 v34, v172, v188
    v_cvt_pk_bf16_f32 v35, v173, v189
    v_mfma_f32_32x32x16_bf16 v[216:231], v[76:79], v[96:99], v[216:231]
    v_cvt_pk_bf16_f32 v36, v174, v190
    v_cvt_pk_bf16_f32 v37, v175, v191
    ds_write_b32 v12, v34 offset:8192
    ds_write_b32 v12, v35 offset:9216
    v_mfma_f32_32x32x16_bf16 v[200:215], v[80:83], v[60:63], v[200:215]
    ds_write_b32 v12, v36 offset:10240
    ds_write_b32 v12, v37 offset:11264
    v_cvt_pk_bf16_f32 v30, v176, v192
    v_cvt_pk_bf16_f32 v31, v177, v193
    v_cvt_pk_bf16_f32 v32, v178, v194
    v_mfma_f32_32x32x16_bf16 v[216:231], v[80:83], v[68:71], v[216:231]
    v_cvt_pk_bf16_f32 v33, v179, v195
    ds_write_b32 v12, v30 offset:16384
    ds_write_b32 v12, v31 offset:17408
    ds_write_b32 v12, v32 offset:18432
    v_mfma_f32_32x32x16_bf16 v[200:215], v[84:87], v[68:71], v[200:215]
    ds_write_b32 v12, v33 offset:19456
    v_cvt_pk_bf16_f32 v34, v180, v196
    v_cvt_pk_bf16_f32 v35, v181, v197
    v_cvt_pk_bf16_f32 v36, v182, v198
    v_cvt_pk_bf16_f32 v37, v183, v199
    v_mfma_f32_32x32x16_bf16 v[216:231], v[84:87], v[100:103], v[216:231]
    ds_write_b32 v12, v34 offset:24576
    ds_write_b32 v12, v35 offset:25600
    ds_write_b32 v12, v36 offset:26624
    ds_write_b32 v12, v37 offset:27648
    s_nop 7
    v_cvt_pk_bf16_f32 v30, v200, v216
    v_cvt_pk_bf16_f32 v31, v201, v217
    v_cvt_pk_bf16_f32 v32, v202, v218
    v_cvt_pk_bf16_f32 v33, v203, v219
    ds_write_b32 v12, v30 offset:512
    ds_write_b32 v12, v31 offset:1536
    ds_write_b32 v12, v32 offset:2560
    ds_write_b32 v12, v33 offset:3584
    v_cvt_pk_bf16_f32 v34, v204, v220
    v_cvt_pk_bf16_f32 v35, v205, v221
    v_cvt_pk_bf16_f32 v36, v206, v222
    v_cvt_pk_bf16_f32 v37, v207, v223
    ds_write_b32 v12, v34 offset:8704
    ds_write_b32 v12, v35 offset:9728
    ds_write_b32 v12, v36 offset:10752
    ds_write_b32 v12, v37 offset:11776
    v_cvt_pk_bf16_f32 v30, v208, v224
    v_cvt_pk_bf16_f32 v31, v209, v225
    v_cvt_pk_bf16_f32 v32, v210, v226
    v_cvt_pk_bf16_f32 v33, v211, v227
    ds_write_b32 v12, v30 offset:16896
    ds_write_b32 v12, v31 offset:17920
    ds_write_b32 v12, v32 offset:18944
    ds_write_b32 v12, v33 offset:19968
    v_cvt_pk_bf16_f32 v34, v212, v228
    v_cvt_pk_bf16_f32 v35, v213, v229
    v_cvt_pk_bf16_f32 v36, v214, v230
    v_cvt_pk_bf16_f32 v37, v215, v231
    ds_write_b32 v12, v34 offset:25088
    ds_write_b32 v12, v35 offset:26112
    ds_write_b32 v12, v36 offset:27136
    ds_write_b32 v12, v37 offset:28160
    s_waitcnt lgkmcnt(0)
    s_barrier
    ds_read_b128 v[104:107], v8 offset:0
    ds_read_b128 v[108:111], v8 offset:8192
    ds_read_b128 v[112:115], v8 offset:16384
    ds_read_b128 v[116:119], v8 offset:24576
    ds_read_b128 v[120:123], v8 offset:32768
    ds_read_b128 v[124:127], v8 offset:40960
    ds_read_b128 v[128:131], v8 offset:49152
    ds_read_b128 v[132:135], v8 offset:57344
    v_bfe_u32 v30, v0, 3, 1
    v_cmp_eq_u32 s[46:47], 1, v30
    v_bfe_u32 v30, v0, 4, 1
    v_cmp_eq_u32 s[48:49], 1, v30
    s_add_u32 s42, s41, 10944512
    s_waitcnt lgkmcnt(7)
    v_cndmask_b32 v168, v104, v105, s[46:47]
    v_cndmask_b32 v169, v105, v104, s[46:47]
    v_cndmask_b32 v170, v106, v107, s[46:47]
    v_cndmask_b32 v171, v107, v106, s[46:47]
    v_cndmask_b32 v104, v168, v170, s[48:49]
    v_cndmask_b32 v105, v169, v171, s[48:49]
    v_cndmask_b32 v106, v170, v168, s[48:49]
    v_cndmask_b32 v107, v171, v169, s[48:49]
    s_add_u32 s43, s42, 0
    buffer_store_dwordx4 v[104:107], v8, s[16:19], s43 offen sc1
    s_waitcnt lgkmcnt(6)
    v_cndmask_b32 v172, v108, v109, s[46:47]
    v_cndmask_b32 v173, v109, v108, s[46:47]
    v_cndmask_b32 v174, v110, v111, s[46:47]
    v_cndmask_b32 v175, v111, v110, s[46:47]
    v_cndmask_b32 v108, v172, v174, s[48:49]
    v_cndmask_b32 v109, v173, v175, s[48:49]
    v_cndmask_b32 v110, v174, v172, s[48:49]
    v_cndmask_b32 v111, v175, v173, s[48:49]
    s_add_u32 s43, s42, 8192
    buffer_store_dwordx4 v[108:111], v8, s[16:19], s43 offen sc1
    s_waitcnt lgkmcnt(5)
    v_cndmask_b32 v176, v112, v113, s[46:47]
    v_cndmask_b32 v177, v113, v112, s[46:47]
    v_cndmask_b32 v178, v114, v115, s[46:47]
    v_cndmask_b32 v179, v115, v114, s[46:47]
    v_cndmask_b32 v112, v176, v178, s[48:49]
    v_cndmask_b32 v113, v177, v179, s[48:49]
    v_cndmask_b32 v114, v178, v176, s[48:49]
    v_cndmask_b32 v115, v179, v177, s[48:49]
    s_add_u32 s43, s42, 16384
    buffer_store_dwordx4 v[112:115], v8, s[16:19], s43 offen sc1
    s_waitcnt lgkmcnt(4)
    v_cndmask_b32 v180, v116, v117, s[46:47]
    v_cndmask_b32 v181, v117, v116, s[46:47]
    v_cndmask_b32 v182, v118, v119, s[46:47]
    v_cndmask_b32 v183, v119, v118, s[46:47]
    v_cndmask_b32 v116, v180, v182, s[48:49]
    v_cndmask_b32 v117, v181, v183, s[48:49]
    v_cndmask_b32 v118, v182, v180, s[48:49]
    v_cndmask_b32 v119, v183, v181, s[48:49]
    s_add_u32 s43, s42, 24576
    buffer_store_dwordx4 v[116:119], v8, s[16:19], s43 offen sc1
    s_waitcnt lgkmcnt(3)
    v_cndmask_b32 v184, v120, v121, s[46:47]
    v_cndmask_b32 v185, v121, v120, s[46:47]
    v_cndmask_b32 v186, v122, v123, s[46:47]
    v_cndmask_b32 v187, v123, v122, s[46:47]
    v_cndmask_b32 v120, v184, v186, s[48:49]
    v_cndmask_b32 v121, v185, v187, s[48:49]
    v_cndmask_b32 v122, v186, v184, s[48:49]
    v_cndmask_b32 v123, v187, v185, s[48:49]
    s_add_u32 s43, s42, 32768
    buffer_store_dwordx4 v[120:123], v8, s[16:19], s43 offen sc1
    s_waitcnt lgkmcnt(2)
    v_cndmask_b32 v188, v124, v125, s[46:47]
    v_cndmask_b32 v189, v125, v124, s[46:47]
    v_cndmask_b32 v190, v126, v127, s[46:47]
    v_cndmask_b32 v191, v127, v126, s[46:47]
    v_cndmask_b32 v124, v188, v190, s[48:49]
    v_cndmask_b32 v125, v189, v191, s[48:49]
    v_cndmask_b32 v126, v190, v188, s[48:49]
    v_cndmask_b32 v127, v191, v189, s[48:49]
    s_add_u32 s43, s42, 40960
    buffer_store_dwordx4 v[124:127], v8, s[16:19], s43 offen sc1
    s_waitcnt lgkmcnt(1)
    v_cndmask_b32 v192, v128, v129, s[46:47]
    v_cndmask_b32 v193, v129, v128, s[46:47]
    v_cndmask_b32 v194, v130, v131, s[46:47]
    v_cndmask_b32 v195, v131, v130, s[46:47]
    v_cndmask_b32 v128, v192, v194, s[48:49]
    v_cndmask_b32 v129, v193, v195, s[48:49]
    v_cndmask_b32 v130, v194, v192, s[48:49]
    v_cndmask_b32 v131, v195, v193, s[48:49]
    s_add_u32 s43, s42, 49152
    buffer_store_dwordx4 v[128:131], v8, s[16:19], s43 offen sc1
    s_waitcnt lgkmcnt(0)
    v_cndmask_b32 v196, v132, v133, s[46:47]
    v_cndmask_b32 v197, v133, v132, s[46:47]
    v_cndmask_b32 v198, v134, v135, s[46:47]
    v_cndmask_b32 v199, v135, v134, s[46:47]
    v_cndmask_b32 v132, v196, v198, s[48:49]
    v_cndmask_b32 v133, v197, v199, s[48:49]
    v_cndmask_b32 v134, v198, v196, s[48:49]
    v_cndmask_b32 v135, v199, v197, s[48:49]
    s_add_u32 s43, s42, 57344
    buffer_store_dwordx4 v[132:135], v8, s[16:19], s43 offen sc1
    s_waitcnt vmcnt(0)
    s_barrier
    s_cmp_eq_u32 s3, 7
    s_cbranch_scc0 K_nofl2f
    s_mul_i32 s58, s35, 32
    s_add_u32 s58, s58, 13631488
    v_mov_b32 v240, s20
    v_mov_b32 v241, s21
    v_mov_b32 v242, 0
    s_mov_b64 s[22:23], exec
    s_mov_b64 exec, 1
    buffer_store_dwordx2 v[240:241], v242, s[16:19], s58 offen sc1
    s_mov_b64 exec, s[22:23]
K_nofl2f:
    s_mov_b32 s4, s76
    s_and_b32 s5, s77, 0xffff
    s_mov_b32 s6, 0x6c0000
    s_mov_b32 s7, 0x20000
    s_cmp_ge_u32 s3, 6
    s_cbranch_scc1 K_p3a_f
    s_mov_b32 s63, s36
    s_mul_i32 s59, s3, 1179648
    s_lshl_b32 s57, s37, 7
    s_add_u32 s59, s59, s57
    s_add_u32 s40, s63, 0
    s_cmp_ge_u32 s40, 9
    s_cselect_b32 s61, 9, 0
    s_sub_u32 s40, s40, s61
    s_mul_i32 s40, s40, 131072
    s_add_u32 s40, s40, s59
    s_add_u32 s41, s63, 1
    s_cmp_ge_u32 s41, 9
    s_cselect_b32 s61, 9, 0
    s_sub_u32 s41, s41, s61
    s_mul_i32 s41, s41, 131072
    s_add_u32 s41, s41, s59
    s_add_u32 s42, s63, 2
    s_cmp_ge_u32 s42, 9
    s_cselect_b32 s61, 9, 0
    s_sub_u32 s42, s42, s61
    s_mul_i32 s42, s42, 131072
    s_add_u32 s42, s42, s59
    s_add_u32 s43, s63, 3
    s_cmp_ge_u32 s43, 9
    s_cselect_b32 s61, 9, 0
    s_sub_u32 s43, s43, s61
    s_mul_i32 s43, s43, 131072
    s_add_u32 s43, s43, s59
    s_add_u32 s44, s63, 4
    s_cmp_ge_u32 s44, 9
    s_cselect_b32 s61, 9, 0
    s_sub_u32 s44, s44, s61
    s_mul_i32 s44, s44, 131072
    s_add_u32 s44, s44, s59
    s_add_u32 s45, s63, 5
    s_cmp_ge_u32 s45, 9
    s_cselect_b32 s61, 9, 0
    s_sub_u32 s45, s45, s61
    s_mul_i32 s45, s45, 131072
    s_add_u32 s45, s45, s59
    s_add_u32 s46, s63, 6
    s_cmp_ge_u32 s46, 9
    s_cselect_b32 s61, 9, 0
    s_sub_u32 s46, s46, s61
    s_mul_i32 s46, s46, 131072
    s_add_u32 s46, s46, s59
    s_add_u32 s47, s63, 7
    s_cmp_ge_u32 s47, 9
    s_cselect_b32 s61, 9, 0
    s_sub_u32 s47, s47, s61
    s_mul_i32 s47, s47, 131072
    s_add_u32 s47, s47, s59
    s_add_u32 s48, s63, 8
    s_cmp_ge_u32 s48, 9
    s_cselect_b32 s61, 9, 0
    s_sub_u32 s48, s48, s61
    s_mul_i32 s48, s48, 131072
    s_add_u32 s48, s48, s59
    s_add_u32 m0, s38, 0
    s_mov_b32 s62, s40
    buffer_load_dwordx4 v4, s[4:7], s62 offen lds
    s_add_u32 m0, s38, 1024
    s_add_u32 s62, s62, 32768
    buffer_load_dwordx4 v4, s[4:7], s62 offen lds
    s_add_u32 m0, s38, 2048
    s_add_u32 s62, s62, 32768
    buffer_load_dwordx4 v4, s[4:7], s62 offen lds
    s_add_u32 m0, s38, 3072
    s_add_u32 s62, s62, 32768
    buffer_load_dwordx4 v4, s[4:7], s62 offen lds
    s_add_u32 m0, s38, 4096
    s_mov_b32 s62, s41
    buffer_load_dwordx4 v4, s[4:7], s62 offen lds
    s_add_u32 m0, s38, 5120
    s_add_u32 s62, s62, 32768
    buffer_load_dwordx4 v4, s[4:7], s62 offen lds
    s_add_u32 m0, s38, 6144
    s_add_u32 s62, s62, 32768
    buffer_load_dwordx4 v4, s[4:7], s62 offen lds
    s_add_u32 m0, s38, 7168
    s_add_u32 s62, s62, 32768
    buffer_load_dwordx4 v4, s[4:7], s62 offen lds
    s_add_u32 m0, s38, 8192
    s_mov_b32 s62, s42
    buffer_load_dwordx4 v4, s[4:7], s62 offen lds
    s_add_u32 m0, s38, 9216
    s_add_u32 s62, s62, 32768
    buffer_load_dwordx4 v4, s[4:7], s62 offen lds
    s_add_u32 m0, s38, 10240
    s_add_u32 s62, s62, 32768
    buffer_load_dwordx4 v4, s[4:7], s62 offen lds
    s_add_u32 m0, s38, 11264
    s_add_u32 s62, s62, 32768
    buffer_load_dwordx4 v4, s[4:7], s62 offen lds
    s_add_u32 m0, s39, 0
    s_mov_b32 s62, s43
    buffer_load_dwordx4 v4, s[4:7], s62 offen lds
    s_add_u32 m0, s39, 1024
    s_add_u32 s62, s62, 32768
    buffer_load_dwordx4 v4, s[4:7], s62 offen lds
    s_add_u32 m0, s39, 2048
    s_add_u32 s62, s62, 32768
    buffer_load_dwordx4 v4, s[4:7], s62 offen lds
    s_add_u32 m0, s39, 3072
    s_add_u32 s62, s62, 32768
    buffer_load_dwordx4 v4, s[4:7], s62 offen lds
    s_add_u32 m0, s39, 32768
    s_mov_b32 s62, s44
    buffer_load_dwordx4 v4, s[4:7], s62 offen lds
    s_add_u32 m0, s39, 33792
    s_add_u32 s62, s62, 32768
    buffer_load_dwordx4 v4, s[4:7], s62 offen lds
    s_add_u32 m0, s39, 34816
    s_add_u32 s62, s62, 32768
    buffer_load_dwordx4 v4, s[4:7], s62 offen lds
    s_add_u32 m0, s39, 35840
    s_add_u32 s62, s62, 32768
    buffer_load_dwordx4 v4, s[4:7], s62 offen lds
K_p3a_f:
K_p3:
    s_mov_b32 s12, s78
    s_and_b32 s13, s79, 0xffff
    s_mov_b32 s14, 0x1000
    s_mov_b32 s15, 0x20000
    s_mov_b32 s24, s82
    s_and_b32 s25, s83, 0xffff
    s_mov_b32 s26, 0x280000
    s_mov_b32 s27, 0x20000
    v_lshlrev_b32 v8, 4, v1
    v_add_u32 v9, s39, v8
    v_lshlrev_b32 v10, 3, v0
    v_add_u32 v10, 98304, v10
    v_lshrrev_b32 v38, 7, v0
    v_bfe_u32 v39, v0, 1, 4
    v_lshl_add_u32 v38, v38, 4, v39
    s_lshl_b32 s58, s37, 6
    v_add_u32 v40, s58, v38
    v_lshlrev_b32 v39, 1, v40
    buffer_load_ushort v14, v39, s[12:15], 0 offen
    v_lshlrev_b32 v16, 3, v40
    s_mov_b32 s56, 7897088
    buffer_load_dwordx2 v[12:13], v16, s[16:19], s56 offen sc1
    v_mul_u32_u24 v11, 176, v38
    v_bfe_u32 v39, v0, 5, 2
    v_lshl_add_u32 v11, v39, 3, v11
    v_and_b32 v39, 1, v0
    v_lshl_add_u32 v11, v39, 2, v11
    s_mov_b32 s89, 0
    s_add_u32 s96, s89, 0
    s_cmp_ge_u32 s96, 5
    s_cselect_b32 s61, 5, 0
    s_sub_u32 s96, s96, s61
    s_mul_i32 s96, s96, 32
    s_add_u32 s97, s89, 1
    s_cmp_ge_u32 s97, 5
    s_cselect_b32 s61, 5, 0
    s_sub_u32 s97, s97, s61
    s_mul_i32 s97, s97, 32
    s_add_u32 s98, s89, 2
    s_cmp_ge_u32 s98, 5
    s_cselect_b32 s61, 5, 0
    s_sub_u32 s98, s98, s61
    s_mul_i32 s98, s98, 32
    s_add_u32 s99, s89, 3
    s_cmp_ge_u32 s99, 5
    s_cselect_b32 s61, 5, 0
    s_sub_u32 s99, s99, s61
    s_mul_i32 s99, s99, 32
    s_add_u32 s100, s89, 4
    s_cmp_ge_u32 s100, 5
    s_cselect_b32 s61, 5, 0
    s_sub_u32 s100, s100, s61
    s_mul_i32 s100, s100, 32
    s_cmp_ge_u32 s3, 6
    s_cbranch_scc1 K_dft
    v_lshrrev_b32 v26, 2, v2
    v_and_b32 v27, 3, v2
    v_lshl_add_u32 v28, v3, 2, v26
    v_and_b32 v29, 6, v28
    v_lshrrev_b32 v30, 1, v27
    v_xor_b32 v30, v30, v29
    v_lshlrev_b32 v30, 4, v30
    v_lshl_add_u32 v30, v28, 7, v30
    v_and_b32 v27, 1, v27
    v_lshl_add_u32 v30, v27, 3, v30
    v_add_u32 v17, s38, v30
    v_xor_b32 v18, 32, v17
    v_xor_b32 v19, 64, v17
    v_xor_b32 v20, 96, v17
    s_lshl_b32 s58, s3, 13
    s_sub_u32 s58, 98304, s58
    v_add_u32 v22, s58, v17
    v_add_u32 v23, s58, v18
    v_add_u32 v24, s58, v19
    v_add_u32 v25, s58, v20
    s_mov_b32 s63, s36
    s_add_u32 s64, s63, 0
    s_cmp_ge_u32 s64, 9
    s_cselect_b32 s61, 9, 0
    s_sub_u32 s64, s64, s61
    s_mul_i32 s64, s64, 40960
    s_add_u32 s65, s63, 1
    s_cmp_ge_u32 s65, 9
    s_cselect_b32 s61, 9, 0
    s_sub_u32 s65, s65, s61
    s_mul_i32 s65, s65, 40960
    s_add_u32 s66, s63, 2
    s_cmp_ge_u32 s66, 9
    s_cselect_b32 s61, 9, 0
    s_sub_u32 s66, s66, s61
    s_mul_i32 s66, s66, 40960
    s_add_u32 s67, s63, 3
    s_cmp_ge_u32 s67, 9
    s_cselect_b32 s61, 9, 0
    s_sub_u32 s67, s67, s61
    s_mul_i32 s67, s67, 40960
    s_add_u32 s68, s63, 4
    s_cmp_ge_u32 s68, 9
    s_cselect_b32 s61, 9, 0
    s_sub_u32 s68, s68, s61
    s_mul_i32 s68, s68, 40960
    s_add_u32 s69, s63, 5
    s_cmp_ge_u32 s69, 9
    s_cselect_b32 s61, 9, 0
    s_sub_u32 s69, s69, s61
    s_mul_i32 s69, s69, 40960
    s_add_u32 s70, s63, 6
    s_cmp_ge_u32 s70, 9
    s_cselect_b32 s61, 9, 0
    s_sub_u32 s70, s70, s61
    s_mul_i32 s70, s70, 40960
    s_add_u32 s71, s63, 7
    s_cmp_ge_u32 s71, 9
    s_cselect_b32 s61, 9, 0
    s_sub_u32 s71, s71, s61
    s_mul_i32 s71, s71, 40960
    s_add_u32 s80, s63, 8
    s_cmp_ge_u32 s80, 9
    s_cselect_b32 s61, 9, 0
    s_sub_u32 s80, s80, s61
    s_mul_i32 s80, s80, 40960
    s_mul_i32 s59, s3, 368640
    s_mul_i32 s58, s36, 5120
    s_add_u32 s59, s59, s58
    s_add_u32 s59, s59, 8732672
    s_add_u32 s49, s89, 0
    s_cmp_ge_u32 s49, 5
    s_cselect_b32 s61, 5, 0
    s_sub_u32 s49, s49, s61
    s_mul_i32 s49, s49, 1024
    s_add_u32 s49, s49, s59
    s_add_u32 s50, s89, 1
    s_cmp_ge_u32 s50, 5
    s_cselect_b32 s61, 5, 0
    s_sub_u32 s50, s50, s61
    s_mul_i32 s50, s50, 1024
    s_add_u32 s50, s50, s59
    s_add_u32 s51, s89, 2
    s_cmp_ge_u32 s51, 5
    s_cselect_b32 s61, 5, 0
    s_sub_u32 s51, s51, s61
    s_mul_i32 s51, s51, 1024
    s_add_u32 s51, s51, s59
    s_add_u32 s52, s89, 3
    s_cmp_ge_u32 s52, 5
    s_cselect_b32 s61, 5, 0
    s_sub_u32 s52, s52, s61
    s_mul_i32 s52, s52, 1024
    s_add_u32 s52, s52, s59
    s_add_u32 s53, s89, 4
    s_cmp_ge_u32 s53, 5
    s_cselect_b32 s61, 5, 0
    s_sub_u32 s53, s53, s61
    s_mul_i32 s53, s53, 1024
    s_add_u32 s53, s53, s59
    s_waitcnt vmcnt(16)
    ds_read_b64_tr_b16 v[76:77], v17 offset:0
    ds_read_b64_tr_b16 v[78:79], v17 offset:2048
    ds_read_b64_tr_b16 v[80:81], v18 offset:0
    ds_read_b64_tr_b16 v[82:83], v18 offset:2048
    ds_read_b64_tr_b16 v[84:85], v19 offset:0
    ds_read_b64_tr_b16 v[86:87], v19 offset:2048
    ds_read_b64_tr_b16 v[88:89], v20 offset:0
    ds_read_b64_tr_b16 v[90:91], v20 offset:2048
    s_waitcnt lgkmcnt(0)
    s_add_u32 m0, s38, 0
    s_mov_b32 s62, s45
    buffer_load_dwordx4 v4, s[4:7], s62 offen lds
    s_add_u32 m0, s38, 1024
    s_add_u32 s62, s62, 32768
    buffer_load_dwordx4 v4, s[4:7], s62 offen lds
    s_add_u32 m0, s38, 2048
    s_add_u32 s62, s62, 32768
    buffer_load_dwordx4 v4, s[4:7], s62 offen lds
    s_add_u32 m0, s38, 3072
    s_add_u32 s62, s62, 32768
    buffer_load_dwordx4 v4, s[4:7], s62 offen lds
    s_waitcnt vmcnt(16)
    ds_read_b64_tr_b16 v[92:93], v17 offset:4096
    ds_read_b64_tr_b16 v[94:95], v17 offset:6144
    ds_read_b64_tr_b16 v[96:97], v18 offset:4096
    ds_read_b64_tr_b16 v[98:99], v18 offset:6144
    ds_read_b64_tr_b16 v[100:101], v19 offset:4096
    ds_read_b64_tr_b16 v[102:103], v19 offset:6144
    ds_read_b64_tr_b16 v[104:105], v20 offset:4096
    ds_read_b64_tr_b16 v[106:107], v20 offset:6144
    s_waitcnt lgkmcnt(0)
    s_add_u32 m0, s38, 4096
    s_mov_b32 s62, s46
    buffer_load_dwordx4 v4, s[4:7], s62 offen lds
    s_add_u32 m0, s38, 5120
    s_add_u32 s62, s62, 32768
    buffer_load_dwordx4 v4, s[4:7], s62 offen lds
    s_add_u32 m0, s38, 6144
    s_add_u32 s62, s62, 32768
    buffer_load_dwordx4 v4, s[4:7], s62 offen lds
    s_add_u32 m0, s38, 7168
    s_add_u32 s62, s62, 32768
    buffer_load_dwordx4 v4, s[4:7], s62 offen lds
    s_waitcnt vmcnt(16)
    ds_read_b64_tr_b16 v[108:109], v17 offset:8192
    ds_read_b64_tr_b16 v[110:111], v17 offset:10240
    ds_read_b64_tr_b16 v[112:113], v18 offset:8192
    ds_read_b64_tr_b16 v[114:115], v18 offset:10240
    ds_read_b64_tr_b16 v[116:117], v19 offset:8192
    ds_read_b64_tr_b16 v[118:119], v19 offset:10240
    ds_read_b64_tr_b16 v[120:121], v20 offset:8192
    ds_read_b64_tr_b16 v[122:123], v20 offset:10240
    s_waitcnt lgkmcnt(0)
    s_add_u32 m0, s38, 8192
    s_mov_b32 s62, s47
    buffer_load_dwordx4 v4, s[4:7], s62 offen lds
    s_add_u32 m0, s38, 9216
    s_add_u32 s62, s62, 32768
    buffer_load_dwordx4 v4, s[4:7], s62 offen lds
    s_add_u32 m0, s38, 10240
    s_add_u32 s62, s62, 32768
    buffer_load_dwordx4 v4, s[4:7], s62 offen lds
    s_add_u32 m0, s38, 11264
    s_add_u32 s62, s62, 32768
    buffer_load_dwordx4 v4, s[4:7], s62 offen lds
    s_waitcnt vmcnt(16)
    ds_read_b64_tr_b16 v[124:125], v22 offset:0
    ds_read_b64_tr_b16 v[126:127], v22 offset:2048
    ds_read_b64_tr_b16 v[128:129], v23 offset:0
    ds_read_b64_tr_b16 v[130:131], v23 offset:2048
    ds_read_b64_tr_b16 v[132:133], v24 offset:0
    ds_read_b64_tr_b16 v[134:135], v24 offset:2048
    ds_read_b64_tr_b16 v[136:137], v25 offset:0
    ds_read_b64_tr_b16 v[138:139], v25 offset:2048
    s_waitcnt lgkmcnt(0)
    s_add_u32 m0, s39, 0
    s_mov_b32 s62, s48
    buffer_load_dwordx4 v4, s[4:7], s62 offen lds
    s_add_u32 m0, s39, 1024
    s_add_u32 s62, s62, 32768
    buffer_load_dwordx4 v4, s[4:7], s62 offen lds
    s_add_u32 m0, s39, 2048
    s_add_u32 s62, s62, 32768
    buffer_load_dwordx4 v4, s[4:7], s62 offen lds
    s_add_u32 m0, s39, 3072
    s_add_u32 s62, s62, 32768
    buffer_load_dwordx4 v4, s[4:7], s62 offen lds
    s_waitcnt vmcnt(16)
    ds_read_b64_tr_b16 v[140:141], v22 offset:32768
    ds_read_b64_tr_b16 v[142:143], v22 offset:34816
    ds_read_b64_tr_b16 v[144:145], v23 offset:32768
    ds_read_b64_tr_b16 v[146:147], v23 offset:34816
    ds_read_b64_tr_b16 v[148:149], v24 offset:32768
    ds_read_b64_tr_b16 v[150:151], v24 offset:34816
    ds_read_b64_tr_b16 v[152:153], v25 offset:32768
    ds_read_b64_tr_b16 v[154:155], v25 offset:34816
    s_waitcnt vmcnt(12)
    ds_read_b64_tr_b16 v[156:157], v17 offset:0
    ds_read_b64_tr_b16 v[158:159], v17 offset:2048
    ds_read_b64_tr_b16 v[160:161], v18 offset:0
    ds_read_b64_tr_b16 v[162:163], v18 offset:2048
    ds_read_b64_tr_b16 v[164:165], v19 offset:0
    ds_read_b64_tr_b16 v[166:167], v19 offset:2048
    ds_read_b64_tr_b16 v[168:169], v20 offset:0
    ds_read_b64_tr_b16 v[170:171], v20 offset:2048
    s_waitcnt vmcnt(8)
    ds_read_b64_tr_b16 v[172:173], v17 offset:4096
    ds_read_b64_tr_b16 v[174:175], v17 offset:6144
    ds_read_b64_tr_b16 v[176:177], v18 offset:4096
    ds_read_b64_tr_b16 v[178:179], v18 offset:6144
    ds_read_b64_tr_b16 v[180:181], v19 offset:4096
    ds_read_b64_tr_b16 v[182:183], v19 offset:6144
    ds_read_b64_tr_b16 v[184:185], v20 offset:4096
    ds_read_b64_tr_b16 v[186:187], v20 offset:6144
    s_waitcnt vmcnt(4)
    ds_read_b64_tr_b16 v[188:189], v17 offset:8192
    ds_read_b64_tr_b16 v[190:191], v17 offset:10240
    ds_read_b64_tr_b16 v[192:193], v18 offset:8192
    ds_read_b64_tr_b16 v[194:195], v18 offset:10240
    ds_read_b64_tr_b16 v[196:197], v19 offset:8192
    ds_read_b64_tr_b16 v[198:199], v19 offset:10240
    ds_read_b64_tr_b16 v[200:201], v20 offset:8192
    ds_read_b64_tr_b16 v[202:203], v20 offset:10240
    s_waitcnt vmcnt(0)
    ds_read_b64_tr_b16 v[204:205], v22 offset:0
    ds_read_b64_tr_b16 v[206:207], v22 offset:2048
    ds_read_b64_tr_b16 v[208:209], v23 offset:0
    ds_read_b64_tr_b16 v[210:211], v23 offset:2048
    ds_read_b64_tr_b16 v[212:213], v24 offset:0
    ds_read_b64_tr_b16 v[214:215], v24 offset:2048
    ds_read_b64_tr_b16 v[216:217], v25 offset:0
    ds_read_b64_tr_b16 v[218:219], v25 offset:2048
    s_waitcnt lgkmcnt(0)
    s_mul_i32 s58, s3, 9
    s_lshr_b32 s58, s58, 1
    s_lshl_b32 s59, s36, 5
    s_add_u32 s58, s58, s59
    s_mul_i32 s58, s58, 32
    s_add_u32 s58, s58, 13598720
    s_mov_b32 s60, 0
Kp3b_nonce:
    v_readfirstlane_b32 s20, v6
    v_readfirstlane_b32 s21, v7
    s_nop 0
    s_cmp_lg_u32 s21, 0
    s_cbranch_scc1 Kp3b_nonceok
    s_add_u32 s60, s60, 1
    s_cmp_lt_u32 s60, 262144
    s_cbranch_scc0 Kp3b_nonceok
    v_mov_b32 v220, 0
    global_load_dwordx2 v[6:7], v220, s[84:85] sc1
    s_waitcnt vmcnt(0)
    s_branch Kp3b_nonce
Kp3b_nonceok:
    v_mul_u32_u24 v220, 32, v1
    s_mov_b32 s60, 0
    v_cmp_gt_u32 vcc, 5, v1
    s_nop 0
    s_and_saveexec_b64 s[22:23], vcc
K_poll_p3u:
    buffer_load_dwordx2 v[222:223], v220, s[16:19], s58 offen sc1
    s_waitcnt vmcnt(0)
    v_cmp_eq_u64 s[54:55], v[222:223], s[20:21]
    s_nop 0
    s_mov_b64 s[56:57], s[54:55]
    s_cmp_eq_u64 s[56:57], exec
    s_cbranch_scc1 K_pollok_p3u
    s_add_u32 s60, s60, 1
    s_cmp_lt_u32 s60, 262144
    s_cbranch_scc0 K_pollok_p3u
    s_sleep 1
    s_branch K_poll_p3u
K_pollok_p3u:
    s_mov_b64 exec, s[22:23]
    v_lshlrev_b32 v14, 16, v14
    s_add_u32 s58, s49, s64
    buffer_load_dwordx4 v[220:223], v8, s[16:19], s58 offen sc1
    s_add_u32 s58, s49, s65
    buffer_load_dwordx4 v[224:227], v8, s[16:19], s58 offen sc1
    s_add_u32 s58, s49, s66
    buffer_load_dwordx4 v[228:231], v8, s[16:19], s58 offen sc1
    s_add_u32 s58, s49, s67
    buffer_load_dwordx4 v[232:235], v8, s[16:19], s58 offen sc1
    s_add_u32 s58, s49, s68
    buffer_load_dwordx4 v[236:239], v8, s[16:19], s58 offen sc1
    s_add_u32 s58, s49, s69
    buffer_load_dwordx4 v[240:243], v8, s[16:19], s58 offen sc1
    s_add_u32 s58, s49, s70
    buffer_load_dwordx4 v[244:247], v8, s[16:19], s58 offen sc1
    s_add_u32 s58, s49, s71
    buffer_load_dwordx4 v[248:251], v8, s[16:19], s58 offen sc1
    s_add_u32 s58, s49, s80
    buffer_load_dwordx4 v[252:255], v8, s[16:19], s58 offen sc1
    s_waitcnt vmcnt(8)
    v_mfma_f32_16x16x32_bf16 v[44:47], v[220:223], v[76:79], 0
    v_mfma_f32_16x16x32_bf16 v[48:51], v[220:223], v[80:83], 0
    v_mfma_f32_16x16x32_bf16 v[52:55], v[220:223], v[84:87], 0
    v_mfma_f32_16x16x32_bf16 v[56:59], v[220:223], v[88:91], 0
    s_add_u32 s58, s50, s64
    buffer_load_dwordx4 v[220:223], v8, s[16:19], s58 offen sc1
    s_waitcnt vmcnt(8)
    v_mfma_f32_16x16x32_bf16 v[44:47], v[224:227], v[92:95], v[44:47]
    v_mfma_f32_16x16x32_bf16 v[48:51], v[224:227], v[96:99], v[48:51]
    v_mfma_f32_16x16x32_bf16 v[52:55], v[224:227], v[100:103], v[52:55]
    v_mfma_f32_16x16x32_bf16 v[56:59], v[224:227], v[104:107], v[56:59]
    s_add_u32 s58, s50, s65
    buffer_load_dwordx4 v[224:227], v8, s[16:19], s58 offen sc1
    s_waitcnt vmcnt(8)
    v_mfma_f32_16x16x32_bf16 v[44:47], v[228:231], v[108:111], v[44:47]
    v_mfma_f32_16x16x32_bf16 v[48:51], v[228:231], v[112:115], v[48:51]
    v_mfma_f32_16x16x32_bf16 v[52:55], v[228:231], v[116:119], v[52:55]
    v_mfma_f32_16x16x32_bf16 v[56:59], v[228:231], v[120:123], v[56:59]
    s_add_u32 s58, s50, s66
    buffer_load_dwordx4 v[228:231], v8, s[16:19], s58 offen sc1
    s_waitcnt vmcnt(8)
    v_mfma_f32_16x16x32_bf16 v[44:47], v[232:235], v[124:127], v[44:47]
    v_mfma_f32_16x16x32_bf16 v[48:51], v[232:235], v[128:131], v[48:51]
    v_mfma_f32_16x16x32_bf16 v[52:55], v[232:235], v[132:135], v[52:55]
    v_mfma_f32_16x16x32_bf16 v[56:59], v[232:235], v[136:139], v[56:59]
    s_add_u32 s58, s50, s67
    buffer_load_dwordx4 v[232:235], v8, s[16:19], s58 offen sc1
    s_waitcnt vmcnt(8)
    v_mfma_f32_16x16x32_bf16 v[44:47], v[236:239], v[140:143], v[44:47]
    v_mfma_f32_16x16x32_bf16 v[48:51], v[236:239], v[144:147], v[48:51]
    v_mfma_f32_16x16x32_bf16 v[52:55], v[236:239], v[148:151], v[52:55]
    v_mfma_f32_16x16x32_bf16 v[56:59], v[236:239], v[152:155], v[56:59]
    s_add_u32 s58, s50, s68
    buffer_load_dwordx4 v[236:239], v8, s[16:19], s58 offen sc1
    s_waitcnt vmcnt(8)
    v_mfma_f32_16x16x32_bf16 v[44:47], v[240:243], v[156:159], v[44:47]
    v_mfma_f32_16x16x32_bf16 v[48:51], v[240:243], v[160:163], v[48:51]
    v_mfma_f32_16x16x32_bf16 v[52:55], v[240:243], v[164:167], v[52:55]
    v_mfma_f32_16x16x32_bf16 v[56:59], v[240:243], v[168:171], v[56:59]
    s_add_u32 s58, s50, s69
    buffer_load_dwordx4 v[240:243], v8, s[16:19], s58 offen sc1
    s_waitcnt vmcnt(8)
    v_mfma_f32_16x16x32_bf16 v[44:47], v[244:247], v[172:175], v[44:47]
    v_mfma_f32_16x16x32_bf16 v[48:51], v[244:247], v[176:179], v[48:51]
    v_mfma_f32_16x16x32_bf16 v[52:55], v[244:247], v[180:183], v[52:55]
    v_mfma_f32_16x16x32_bf16 v[56:59], v[244:247], v[184:187], v[56:59]
    s_add_u32 s58, s50, s70
    buffer_load_dwordx4 v[244:247], v8, s[16:19], s58 offen sc1
    s_waitcnt vmcnt(8)
    v_mfma_f32_16x16x32_bf16 v[44:47], v[248:251], v[188:191], v[44:47]
    v_mfma_f32_16x16x32_bf16 v[48:51], v[248:251], v[192:195], v[48:51]
    v_mfma_f32_16x16x32_bf16 v[52:55], v[248:251], v[196:199], v[52:55]
    v_mfma_f32_16x16x32_bf16 v[56:59], v[248:251], v[200:203], v[56:59]
    s_add_u32 s58, s50, s71
    buffer_load_dwordx4 v[248:251], v8, s[16:19], s58 offen sc1
    s_waitcnt vmcnt(8)
    v_mfma_f32_16x16x32_bf16 v[44:47], v[252:255], v[204:207], v[44:47]
    v_mfma_f32_16x16x32_bf16 v[48:51], v[252:255], v[208:211], v[48:51]
    v_mfma_f32_16x16x32_bf16 v[52:55], v[252:255], v[212:215], v[52:55]
    v_mfma_f32_16x16x32_bf16 v[56:59], v[252:255], v[216:219], v[56:59]
    s_add_u32 s58, s50, s80
    buffer_load_dwordx4 v[252:255], v8, s[16:19], s58 offen sc1
    s_waitcnt vmcnt(8)
    v_mfma_f32_16x16x32_bf16 v[60:63], v[220:223], v[76:79], 0
    v_mfma_f32_16x16x32_bf16 v[64:67], v[220:223], v[80:83], 0
    v_mfma_f32_16x16x32_bf16 v[68:71], v[220:223], v[84:87], 0
    v_mfma_f32_16x16x32_bf16 v[72:75], v[220:223], v[88:91], 0
    s_add_u32 s58, s51, s64
    buffer_load_dwordx4 v[220:223], v8, s[16:19], s58 offen sc1
    s_waitcnt vmcnt(8)
    v_mfma_f32_16x16x32_bf16 v[60:63], v[224:227], v[92:95], v[60:63]
    v_mfma_f32_16x16x32_bf16 v[64:67], v[224:227], v[96:99], v[64:67]
    v_mfma_f32_16x16x32_bf16 v[68:71], v[224:227], v[100:103], v[68:71]
    v_mfma_f32_16x16x32_bf16 v[72:75], v[224:227], v[104:107], v[72:75]
    s_add_u32 s58, s51, s65
    buffer_load_dwordx4 v[224:227], v8, s[16:19], s58 offen sc1
    s_waitcnt vmcnt(8)
    v_mfma_f32_16x16x32_bf16 v[60:63], v[228:231], v[108:111], v[60:63]
    ds_write_b128 v9, v[44:47] offset:0
    ds_write_b128 v9, v[48:51] offset:1024
    v_mfma_f32_16x16x32_bf16 v[64:67], v[228:231], v[112:115], v[64:67]
    ds_write_b128 v9, v[52:55] offset:2048
    ds_write_b128 v9, v[56:59] offset:3072
    v_mfma_f32_16x16x32_bf16 v[68:71], v[228:231], v[116:119], v[68:71]
    v_mfma_f32_16x16x32_bf16 v[72:75], v[228:231], v[120:123], v[72:75]
    s_add_u32 s58, s51, s66
    buffer_load_dwordx4 v[228:231], v8, s[16:19], s58 offen sc1
    s_waitcnt vmcnt(8)
    v_mfma_f32_16x16x32_bf16 v[60:63], v[232:235], v[124:127], v[60:63]
    s_waitcnt lgkmcnt(0)
    s_barrier
    v_mfma_f32_16x16x32_bf16 v[64:67], v[232:235], v[128:131], v[64:67]
    ds_read2st64_b64 v[22:25], v10 offset0:0 offset1:8
    ds_read2st64_b64 v[26:29], v10 offset0:16 offset1:24
    v_mfma_f32_16x16x32_bf16 v[68:71], v[232:235], v[132:135], v[68:71]
    ds_read2st64_b64 v[30:33], v10 offset0:32 offset1:40
    ds_read2st64_b64 v[34:37], v10 offset0:48 offset1:56
    v_mfma_f32_16x16x32_bf16 v[72:75], v[232:235], v[136:139], v[72:75]
    v_add_u32 v15, s96, v11
    s_add_u32 s58, s51, s67
    buffer_load_dwordx4 v[232:235], v8, s[16:19], s58 offen sc1
    s_waitcnt vmcnt(8)
    v_mfma_f32_16x16x32_bf16 v[60:63], v[236:239], v[140:143], v[60:63]
    v_mfma_f32_16x16x32_bf16 v[64:67], v[236:239], v[144:147], v[64:67]
    v_mfma_f32_16x16x32_bf16 v[68:71], v[236:239], v[148:151], v[68:71]
    v_mfma_f32_16x16x32_bf16 v[72:75], v[236:239], v[152:155], v[72:75]
    s_add_u32 s58, s51, s68
    buffer_load_dwordx4 v[236:239], v8, s[16:19], s58 offen sc1
    s_waitcnt vmcnt(8)
    v_mfma_f32_16x16x32_bf16 v[60:63], v[240:243], v[156:159], v[60:63]
    s_waitcnt lgkmcnt(0)
    v_add_f32 v22, v22, v24
    v_mfma_f32_16x16x32_bf16 v[64:67], v[240:243], v[160:163], v[64:67]
    v_add_f32 v23, v23, v25
    v_add_f32 v26, v26, v28
    v_mfma_f32_16x16x32_bf16 v[68:71], v[240:243], v[164:167], v[68:71]
    v_add_f32 v27, v27, v29
    v_add_f32 v30, v30, v32
    v_mfma_f32_16x16x32_bf16 v[72:75], v[240:243], v[168:171], v[72:75]
    v_add_f32 v31, v31, v33
    v_add_f32 v34, v34, v36
    s_add_u32 s58, s51, s69
    buffer_load_dwordx4 v[240:243], v8, s[16:19], s58 offen sc1
    s_waitcnt vmcnt(8)
    v_mfma_f32_16x16x32_bf16 v[60:63], v[244:247], v[172:175], v[60:63]
    v_add_f32 v35, v35, v37
    v_add_f32 v22, v22, v26
    v_mfma_f32_16x16x32_bf16 v[64:67], v[244:247], v[176:179], v[64:67]
    v_add_f32 v23, v23, v27
    v_add_f32 v22, v22, v30
    v_mfma_f32_16x16x32_bf16 v[68:71], v[244:247], v[180:183], v[68:71]
    v_add_f32 v23, v23, v31
    v_add_f32 v22, v22, v14
    v_mfma_f32_16x16x32_bf16 v[72:75], v[244:247], v[184:187], v[72:75]
    v_add_f32 v23, v23, v14
    v_mul_f32 v38, v22, v13
    s_add_u32 s58, s51, s70
    buffer_load_dwordx4 v[244:247], v8, s[16:19], s58 offen sc1
    s_waitcnt vmcnt(8)
    v_mfma_f32_16x16x32_bf16 v[60:63], v[248:251], v[188:191], v[60:63]
    v_mul_f32 v39, v23, v13
    v_fmac_f32 v38, v34, v12
    v_mfma_f32_16x16x32_bf16 v[64:67], v[248:251], v[192:195], v[64:67]
    v_fmac_f32 v39, v35, v12
    v_cvt_pk_bf16_f32 v40, v38, v39
    v_mfma_f32_16x16x32_bf16 v[68:71], v[248:251], v[196:199], v[68:71]
    ds_write_b32 v15, v40
    v_mfma_f32_16x16x32_bf16 v[72:75], v[248:251], v[200:203], v[72:75]
    s_add_u32 s58, s51, s71
    buffer_load_dwordx4 v[248:251], v8, s[16:19], s58 offen sc1
    s_waitcnt vmcnt(8)
    v_mfma_f32_16x16x32_bf16 v[60:63], v[252:255], v[204:207], v[60:63]
    v_mfma_f32_16x16x32_bf16 v[64:67], v[252:255], v[208:211], v[64:67]
    v_mfma_f32_16x16x32_bf16 v[68:71], v[252:255], v[212:215], v[68:71]
    v_mfma_f32_16x16x32_bf16 v[72:75], v[252:255], v[216:219], v[72:75]
    s_add_u32 s58, s51, s80
    buffer_load_dwordx4 v[252:255], v8, s[16:19], s58 offen sc1
    s_waitcnt vmcnt(8)
    v_mfma_f32_16x16x32_bf16 v[44:47], v[220:223], v[76:79], 0
    v_mfma_f32_16x16x32_bf16 v[48:51], v[220:223], v[80:83], 0
    v_mfma_f32_16x16x32_bf16 v[52:55], v[220:223], v[84:87], 0
    v_mfma_f32_16x16x32_bf16 v[56:59], v[220:223], v[88:91], 0
    s_add_u32 s58, s52, s64
    buffer_load_dwordx4 v[220:223], v8, s[16:19], s58 offen sc1
    s_waitcnt vmcnt(8)
    v_mfma_f32_16x16x32_bf16 v[44:47], v[224:227], v[92:95], v[44:47]
    v_mfma_f32_16x16x32_bf16 v[48:51], v[224:227], v[96:99], v[48:51]
    v_mfma_f32_16x16x32_bf16 v[52:55], v[224:227], v[100:103], v[52:55]
    v_mfma_f32_16x16x32_bf16 v[56:59], v[224:227], v[104:107], v[56:59]
    s_add_u32 s58, s52, s65
    buffer_load_dwordx4 v[224:227], v8, s[16:19], s58 offen sc1
    s_waitcnt vmcnt(8)
    v_mfma_f32_16x16x32_bf16 v[44:47], v[228:231], v[108:111], v[44:47]
    ds_write_b128 v9, v[60:63] offset:32768
    ds_write_b128 v9, v[64:67] offset:33792
    v_mfma_f32_16x16x32_bf16 v[48:51], v[228:231], v[112:115], v[48:51]
    ds_write_b128 v9, v[68:71] offset:34816
    ds_write_b128 v9, v[72:75] offset:35840
    v_mfma_f32_16x16x32_bf16 v[52:55], v[228:231], v[116:119], v[52:55]
    v_mfma_f32_16x16x32_bf16 v[56:59], v[228:231], v[120:123], v[56:59]
    s_add_u32 s58, s52, s66
    buffer_load_dwordx4 v[228:231], v8, s[16:19], s58 offen sc1
    s_waitcnt vmcnt(8)
    v_mfma_f32_16x16x32_bf16 v[44:47], v[232:235], v[124:127], v[44:47]
    s_waitcnt lgkmcnt(0)
    s_barrier
    v_mfma_f32_16x16x32_bf16 v[48:51], v[232:235], v[128:131], v[48:51]
    ds_read2st64_b64 v[22:25], v10 offset0:64 offset1:72
    ds_read2st64_b64 v[26:29], v10 offset0:80 offset1:88
    v_mfma_f32_16x16x32_bf16 v[52:55], v[232:235], v[132:135], v[52:55]
    ds_read2st64_b64 v[30:33], v10 offset0:96 offset1:104
    ds_read2st64_b64 v[34:37], v10 offset0:112 offset1:120
    v_mfma_f32_16x16x32_bf16 v[56:59], v[232:235], v[136:139], v[56:59]
    v_add_u32 v15, s97, v11
    s_add_u32 s58, s52, s67
    buffer_load_dwordx4 v[232:235], v8, s[16:19], s58 offen sc1
    s_waitcnt vmcnt(8)
    v_mfma_f32_16x16x32_bf16 v[44:47], v[236:239], v[140:143], v[44:47]
    v_mfma_f32_16x16x32_bf16 v[48:51], v[236:239], v[144:147], v[48:51]
    v_mfma_f32_16x16x32_bf16 v[52:55], v[236:239], v[148:151], v[52:55]
    v_mfma_f32_16x16x32_bf16 v[56:59], v[236:239], v[152:155], v[56:59]
    s_add_u32 s58, s52, s68
    buffer_load_dwordx4 v[236:239], v8, s[16:19], s58 offen sc1
    s_waitcnt vmcnt(8)
    v_mfma_f32_16x16x32_bf16 v[44:47], v[240:243], v[156:159], v[44:47]
    s_waitcnt lgkmcnt(0)
    v_add_f32 v22, v22, v24
    v_mfma_f32_16x16x32_bf16 v[48:51], v[240:243], v[160:163], v[48:51]
    v_add_f32 v23, v23, v25
    v_add_f32 v26, v26, v28
    v_mfma_f32_16x16x32_bf16 v[52:55], v[240:243], v[164:167], v[52:55]
    v_add_f32 v27, v27, v29
    v_add_f32 v30, v30, v32
    v_mfma_f32_16x16x32_bf16 v[56:59], v[240:243], v[168:171], v[56:59]
    v_add_f32 v31, v31, v33
    v_add_f32 v34, v34, v36
    s_add_u32 s58, s52, s69
    buffer_load_dwordx4 v[240:243], v8, s[16:19], s58 offen sc1
    s_waitcnt vmcnt(8)
    v_mfma_f32_16x16x32_bf16 v[44:47], v[244:247], v[172:175], v[44:47]
    v_add_f32 v35, v35, v37
    v_add_f32 v22, v22, v26
    v_mfma_f32_16x16x32_bf16 v[48:51], v[244:247], v[176:179], v[48:51]
    v_add_f32 v23, v23, v27
    v_add_f32 v22, v22, v30
    v_mfma_f32_16x16x32_bf16 v[52:55], v[244:247], v[180:183], v[52:55]
    v_add_f32 v23, v23, v31
    v_add_f32 v22, v22, v14
    v_mfma_f32_16x16x32_bf16 v[56:59], v[244:247], v[184:187], v[56:59]
    v_add_f32 v23, v23, v14
    v_mul_f32 v38, v22, v13
    s_add_u32 s58, s52, s70
    buffer_load_dwordx4 v[244:247], v8, s[16:19], s58 offen sc1
    s_waitcnt vmcnt(8)
    v_mfma_f32_16x16x32_bf16 v[44:47], v[248:251], v[188:191], v[44:47]
    v_mul_f32 v39, v23, v13
    v_fmac_f32 v38, v34, v12
    v_mfma_f32_16x16x32_bf16 v[48:51], v[248:251], v[192:195], v[48:51]
    v_fmac_f32 v39, v35, v12
    v_cvt_pk_bf16_f32 v40, v38, v39
    v_mfma_f32_16x16x32_bf16 v[52:55], v[248:251], v[196:199], v[52:55]
    ds_write_b32 v15, v40
    v_mfma_f32_16x16x32_bf16 v[56:59], v[248:251], v[200:203], v[56:59]
    s_add_u32 s58, s52, s71
    buffer_load_dwordx4 v[248:251], v8, s[16:19], s58 offen sc1
    s_waitcnt vmcnt(8)
    v_mfma_f32_16x16x32_bf16 v[44:47], v[252:255], v[204:207], v[44:47]
    v_mfma_f32_16x16x32_bf16 v[48:51], v[252:255], v[208:211], v[48:51]
    v_mfma_f32_16x16x32_bf16 v[52:55], v[252:255], v[212:215], v[52:55]
    v_mfma_f32_16x16x32_bf16 v[56:59], v[252:255], v[216:219], v[56:59]
    s_add_u32 s58, s52, s80
    buffer_load_dwordx4 v[252:255], v8, s[16:19], s58 offen sc1
    s_waitcnt vmcnt(8)
    v_mfma_f32_16x16x32_bf16 v[60:63], v[220:223], v[76:79], 0
    v_mfma_f32_16x16x32_bf16 v[64:67], v[220:223], v[80:83], 0
    v_mfma_f32_16x16x32_bf16 v[68:71], v[220:223], v[84:87], 0
    v_mfma_f32_16x16x32_bf16 v[72:75], v[220:223], v[88:91], 0
    s_add_u32 s58, s53, s64
    buffer_load_dwordx4 v[220:223], v8, s[16:19], s58 offen sc1
    s_waitcnt vmcnt(8)
    v_mfma_f32_16x16x32_bf16 v[60:63], v[224:227], v[92:95], v[60:63]
    v_mfma_f32_16x16x32_bf16 v[64:67], v[224:227], v[96:99], v[64:67]
    v_mfma_f32_16x16x32_bf16 v[68:71], v[224:227], v[100:103], v[68:71]
    v_mfma_f32_16x16x32_bf16 v[72:75], v[224:227], v[104:107], v[72:75]
    s_add_u32 s58, s53, s65
    buffer_load_dwordx4 v[224:227], v8, s[16:19], s58 offen sc1
    s_waitcnt vmcnt(8)
    v_mfma_f32_16x16x32_bf16 v[60:63], v[228:231], v[108:111], v[60:63]
    ds_write_b128 v9, v[44:47] offset:0
    ds_write_b128 v9, v[48:51] offset:1024
    v_mfma_f32_16x16x32_bf16 v[64:67], v[228:231], v[112:115], v[64:67]
    ds_write_b128 v9, v[52:55] offset:2048
    ds_write_b128 v9, v[56:59] offset:3072
    v_mfma_f32_16x16x32_bf16 v[68:71], v[228:231], v[116:119], v[68:71]
    v_mfma_f32_16x16x32_bf16 v[72:75], v[228:231], v[120:123], v[72:75]
    s_add_u32 s58, s53, s66
    buffer_load_dwordx4 v[228:231], v8, s[16:19], s58 offen sc1
    s_waitcnt vmcnt(8)
    v_mfma_f32_16x16x32_bf16 v[60:63], v[232:235], v[124:127], v[60:63]
    s_waitcnt lgkmcnt(0)
    s_barrier
    v_mfma_f32_16x16x32_bf16 v[64:67], v[232:235], v[128:131], v[64:67]
    ds_read2st64_b64 v[22:25], v10 offset0:0 offset1:8
    ds_read2st64_b64 v[26:29], v10 offset0:16 offset1:24
    v_mfma_f32_16x16x32_bf16 v[68:71], v[232:235], v[132:135], v[68:71]
    ds_read2st64_b64 v[30:33], v10 offset0:32 offset1:40
    ds_read2st64_b64 v[34:37], v10 offset0:48 offset1:56
    v_mfma_f32_16x16x32_bf16 v[72:75], v[232:235], v[136:139], v[72:75]
    v_add_u32 v15, s98, v11
    s_add_u32 s58, s53, s67
    buffer_load_dwordx4 v[232:235], v8, s[16:19], s58 offen sc1
    s_waitcnt vmcnt(8)
    v_mfma_f32_16x16x32_bf16 v[60:63], v[236:239], v[140:143], v[60:63]
    v_mfma_f32_16x16x32_bf16 v[64:67], v[236:239], v[144:147], v[64:67]
    v_mfma_f32_16x16x32_bf16 v[68:71], v[236:239], v[148:151], v[68:71]
    v_mfma_f32_16x16x32_bf16 v[72:75], v[236:239], v[152:155], v[72:75]
    s_add_u32 s58, s53, s68
    buffer_load_dwordx4 v[236:239], v8, s[16:19], s58 offen sc1
    s_waitcnt vmcnt(8)
    v_mfma_f32_16x16x32_bf16 v[60:63], v[240:243], v[156:159], v[60:63]
    s_waitcnt lgkmcnt(0)
    v_add_f32 v22, v22, v24
    v_mfma_f32_16x16x32_bf16 v[64:67], v[240:243], v[160:163], v[64:67]
    v_add_f32 v23, v23, v25
    v_add_f32 v26, v26, v28
    v_mfma_f32_16x16x32_bf16 v[68:71], v[240:243], v[164:167], v[68:71]
    v_add_f32 v27, v27, v29
    v_add_f32 v30, v30, v32
    v_mfma_f32_16x16x32_bf16 v[72:75], v[240:243], v[168:171], v[72:75]
    v_add_f32 v31, v31, v33
    v_add_f32 v34, v34, v36
    s_add_u32 s58, s53, s69
    buffer_load_dwordx4 v[240:243], v8, s[16:19], s58 offen sc1
    s_waitcnt vmcnt(8)
    v_mfma_f32_16x16x32_bf16 v[60:63], v[244:247], v[172:175], v[60:63]
    v_add_f32 v35, v35, v37
    v_add_f32 v22, v22, v26
    v_mfma_f32_16x16x32_bf16 v[64:67], v[244:247], v[176:179], v[64:67]
    v_add_f32 v23, v23, v27
    v_add_f32 v22, v22, v30
    v_mfma_f32_16x16x32_bf16 v[68:71], v[244:247], v[180:183], v[68:71]
    v_add_f32 v23, v23, v31
    v_add_f32 v22, v22, v14
    v_mfma_f32_16x16x32_bf16 v[72:75], v[244:247], v[184:187], v[72:75]
    v_add_f32 v23, v23, v14
    v_mul_f32 v38, v22, v13
    s_add_u32 s58, s53, s70
    buffer_load_dwordx4 v[244:247], v8, s[16:19], s58 offen sc1
    s_waitcnt vmcnt(8)
    v_mfma_f32_16x16x32_bf16 v[60:63], v[248:251], v[188:191], v[60:63]
    v_mul_f32 v39, v23, v13
    v_fmac_f32 v38, v34, v12
    v_mfma_f32_16x16x32_bf16 v[64:67], v[248:251], v[192:195], v[64:67]
    v_fmac_f32 v39, v35, v12
    v_cvt_pk_bf16_f32 v40, v38, v39
    v_mfma_f32_16x16x32_bf16 v[68:71], v[248:251], v[196:199], v[68:71]
    ds_write_b32 v15, v40
    v_mfma_f32_16x16x32_bf16 v[72:75], v[248:251], v[200:203], v[72:75]
    s_add_u32 s58, s53, s71
    buffer_load_dwordx4 v[248:251], v8, s[16:19], s58 offen sc1
    s_waitcnt vmcnt(8)
    v_mfma_f32_16x16x32_bf16 v[60:63], v[252:255], v[204:207], v[60:63]
    v_mfma_f32_16x16x32_bf16 v[64:67], v[252:255], v[208:211], v[64:67]
    v_mfma_f32_16x16x32_bf16 v[68:71], v[252:255], v[212:215], v[68:71]
    v_mfma_f32_16x16x32_bf16 v[72:75], v[252:255], v[216:219], v[72:75]
    s_add_u32 s58, s53, s80
    buffer_load_dwordx4 v[252:255], v8, s[16:19], s58 offen sc1
    s_waitcnt vmcnt(8)
    v_mfma_f32_16x16x32_bf16 v[44:47], v[220:223], v[76:79], 0
    v_mfma_f32_16x16x32_bf16 v[48:51], v[220:223], v[80:83], 0
    v_mfma_f32_16x16x32_bf16 v[52:55], v[220:223], v[84:87], 0
    v_mfma_f32_16x16x32_bf16 v[56:59], v[220:223], v[88:91], 0
    s_waitcnt vmcnt(7)
    v_mfma_f32_16x16x32_bf16 v[44:47], v[224:227], v[92:95], v[44:47]
    v_mfma_f32_16x16x32_bf16 v[48:51], v[224:227], v[96:99], v[48:51]
    v_mfma_f32_16x16x32_bf16 v[52:55], v[224:227], v[100:103], v[52:55]
    v_mfma_f32_16x16x32_bf16 v[56:59], v[224:227], v[104:107], v[56:59]
    s_waitcnt vmcnt(6)
    v_mfma_f32_16x16x32_bf16 v[44:47], v[228:231], v[108:111], v[44:47]
    ds_write_b128 v9, v[60:63] offset:32768
    ds_write_b128 v9, v[64:67] offset:33792
    v_mfma_f32_16x16x32_bf16 v[48:51], v[228:231], v[112:115], v[48:51]
    ds_write_b128 v9, v[68:71] offset:34816
    ds_write_b128 v9, v[72:75] offset:35840
    v_mfma_f32_16x16x32_bf16 v[52:55], v[228:231], v[116:119], v[52:55]
    v_mfma_f32_16x16x32_bf16 v[56:59], v[228:231], v[120:123], v[56:59]
    s_waitcnt vmcnt(5)
    v_mfma_f32_16x16x32_bf16 v[44:47], v[232:235], v[124:127], v[44:47]
    s_waitcnt lgkmcnt(0)
    s_barrier
    v_mfma_f32_16x16x32_bf16 v[48:51], v[232:235], v[128:131], v[48:51]
    ds_read2st64_b64 v[22:25], v10 offset0:64 offset1:72
    ds_read2st64_b64 v[26:29], v10 offset0:80 offset1:88
    v_mfma_f32_16x16x32_bf16 v[52:55], v[232:235], v[132:135], v[52:55]
    ds_read2st64_b64 v[30:33], v10 offset0:96 offset1:104
    ds_read2st64_b64 v[34:37], v10 offset0:112 offset1:120
    v_mfma_f32_16x16x32_bf16 v[56:59], v[232:235], v[136:139], v[56:59]
    v_add_u32 v15, s99, v11
    s_waitcnt vmcnt(4)
    v_mfma_f32_16x16x32_bf16 v[44:47], v[236:239], v[140:143], v[44:47]
    v_mfma_f32_16x16x32_bf16 v[48:51], v[236:239], v[144:147], v[48:51]
    v_mfma_f32_16x16x32_bf16 v[52:55], v[236:239], v[148:151], v[52:55]
    v_mfma_f32_16x16x32_bf16 v[56:59], v[236:239], v[152:155], v[56:59]
    s_waitcnt vmcnt(3)
    v_mfma_f32_16x16x32_bf16 v[44:47], v[240:243], v[156:159], v[44:47]
    s_waitcnt lgkmcnt(0)
    v_add_f32 v22, v22, v24
    v_mfma_f32_16x16x32_bf16 v[48:51], v[240:243], v[160:163], v[48:51]
    v_add_f32 v23, v23, v25
    v_add_f32 v26, v26, v28
    v_mfma_f32_16x16x32_bf16 v[52:55], v[240:243], v[164:167], v[52:55]
    v_add_f32 v27, v27, v29
    v_add_f32 v30, v30, v32
    v_mfma_f32_16x16x32_bf16 v[56:59], v[240:243], v[168:171], v[56:59]
    v_add_f32 v31, v31, v33
    v_add_f32 v34, v34, v36
    s_waitcnt vmcnt(2)
    v_mfma_f32_16x16x32_bf16 v[44:47], v[244:247], v[172:175], v[44:47]
    v_add_f32 v35, v35, v37
    v_add_f32 v22, v22, v26
    v_mfma_f32_16x16x32_bf16 v[48:51], v[244:247], v[176:179], v[48:51]
    v_add_f32 v23, v23, v27
    v_add_f32 v22, v22, v30
    v_mfma_f32_16x16x32_bf16 v[52:55], v[244:247], v[180:183], v[52:55]
    v_add_f32 v23, v23, v31
    v_add_f32 v22, v22, v14
    v_mfma_f32_16x16x32_bf16 v[56:59], v[244:247], v[184:187], v[56:59]
    v_add_f32 v23, v23, v14
    v_mul_f32 v38, v22, v13
    s_waitcnt vmcnt(1)
    v_mfma_f32_16x16x32_bf16 v[44:47], v[248:251], v[188:191], v[44:47]
    v_mul_f32 v39, v23, v13
    v_fmac_f32 v38, v34, v12
    v_mfma_f32_16x16x32_bf16 v[48:51], v[248:251], v[192:195], v[48:51]
    v_fmac_f32 v39, v35, v12
    v_cvt_pk_bf16_f32 v40, v38, v39
    v_mfma_f32_16x16x32_bf16 v[52:55], v[248:251], v[196:199], v[52:55]
    ds_write_b32 v15, v40
    v_mfma_f32_16x16x32_bf16 v[56:59], v[248:251], v[200:203], v[56:59]
    s_waitcnt vmcnt(0)
    v_mfma_f32_16x16x32_bf16 v[44:47], v[252:255], v[204:207], v[44:47]
    v_mfma_f32_16x16x32_bf16 v[48:51], v[252:255], v[208:211], v[48:51]
    v_mfma_f32_16x16x32_bf16 v[52:55], v[252:255], v[212:215], v[52:55]
    v_mfma_f32_16x16x32_bf16 v[56:59], v[252:255], v[216:219], v[56:59]
    s_nop 4
    ds_write_b128 v9, v[44:47] offset:0
    ds_write_b128 v9, v[48:51] offset:1024
    ds_write_b128 v9, v[52:55] offset:2048
    ds_write_b128 v9, v[56:59] offset:3072
    s_waitcnt lgkmcnt(0)
    s_barrier
    ds_read2st64_b64 v[22:25], v10 offset0:0 offset1:8
    ds_read2st64_b64 v[26:29], v10 offset0:16 offset1:24
    ds_read2st64_b64 v[30:33], v10 offset0:32 offset1:40
    ds_read2st64_b64 v[34:37], v10 offset0:48 offset1:56
    v_add_u32 v15, s100, v11
    s_waitcnt lgkmcnt(0)
    v_add_f32 v22, v22, v24
    v_add_f32 v23, v23, v25
    v_add_f32 v26, v26, v28
    v_add_f32 v27, v27, v29
    v_add_f32 v30, v30, v32
    v_add_f32 v31, v31, v33
    v_add_f32 v34, v34, v36
    v_add_f32 v35, v35, v37
    v_add_f32 v22, v22, v26
    v_add_f32 v23, v23, v27
    v_add_f32 v22, v22, v30
    v_add_f32 v23, v23, v31
    v_add_f32 v22, v22, v14
    v_add_f32 v23, v23, v14
    v_mul_f32 v38, v22, v13
    v_mul_f32 v39, v23, v13
    v_fmac_f32 v38, v34, v12
    v_fmac_f32 v39, v35, v12
    v_cvt_pk_bf16_f32 v40, v38, v39
    ds_write_b32 v15, v40
    s_branch K_fin
K_dft:
    v_lshlrev_b32 v76, 15, v3
    v_lshl_add_u32 v76, v2, 4, v76
    v_add_u32 v77, s38, v8
    s_sub_u32 s55, s3, 6
    s_mov_b32 s63, s36
    s_add_u32 s64, s63, 0
    s_cmp_ge_u32 s64, 10
    s_cselect_b32 s61, 10, 0
    s_sub_u32 s64, s64, s61
    s_mul_i32 s64, s64, 40960
    s_add_u32 s65, s63, 1
    s_cmp_ge_u32 s65, 10
    s_cselect_b32 s61, 10, 0
    s_sub_u32 s65, s65, s61
    s_mul_i32 s65, s65, 40960
    s_add_u32 s66, s63, 2
    s_cmp_ge_u32 s66, 10
    s_cselect_b32 s61, 10, 0
    s_sub_u32 s66, s66, s61
    s_mul_i32 s66, s66, 40960
    s_add_u32 s67, s63, 3
    s_cmp_ge_u32 s67, 10
    s_cselect_b32 s61, 10, 0
    s_sub_u32 s67, s67, s61
    s_mul_i32 s67, s67, 40960
    s_add_u32 s68, s63, 4
    s_cmp_ge_u32 s68, 10
    s_cselect_b32 s61, 10, 0
    s_sub_u32 s68, s68, s61
    s_mul_i32 s68, s68, 40960
    s_add_u32 s69, s63, 5
    s_cmp_ge_u32 s69, 10
    s_cselect_b32 s61, 10, 0
    s_sub_u32 s69, s69, s61
    s_mul_i32 s69, s69, 40960
    s_add_u32 s70, s63, 6
    s_cmp_ge_u32 s70, 10
    s_cselect_b32 s61, 10, 0
    s_sub_u32 s70, s70, s61
    s_mul_i32 s70, s70, 40960
    s_add_u32 s71, s63, 7
    s_cmp_ge_u32 s71, 10
    s_cselect_b32 s61, 10, 0
    s_sub_u32 s71, s71, s61
    s_mul_i32 s71, s71, 40960
    s_add_u32 s80, s63, 8
    s_cmp_ge_u32 s80, 10
    s_cselect_b32 s61, 10, 0
    s_sub_u32 s80, s80, s61
    s_mul_i32 s80, s80, 40960
    s_add_u32 s81, s63, 9
    s_cmp_ge_u32 s81, 10
    s_cselect_b32 s61, 10, 0
    s_sub_u32 s81, s81, s61
    s_mul_i32 s81, s81, 40960
    s_mul_i32 s59, s55, 409600
    s_mul_i32 s58, s36, 5120
    s_add_u32 s59, s59, s58
    s_add_u32 s59, s59, 7913472
    s_add_u32 s49, s89, 0
    s_cmp_ge_u32 s49, 5
    s_cselect_b32 s61, 5, 0
    s_sub_u32 s49, s49, s61
    s_mul_i32 s49, s49, 1024
    s_add_u32 s49, s49, s59
    s_add_u32 s50, s89, 1
    s_cmp_ge_u32 s50, 5
    s_cselect_b32 s61, 5, 0
    s_sub_u32 s50, s50, s61
    s_mul_i32 s50, s50, 1024
    s_add_u32 s50, s50, s59
    s_add_u32 s51, s89, 2
    s_cmp_ge_u32 s51, 5
    s_cselect_b32 s61, 5, 0
    s_sub_u32 s51, s51, s61
    s_mul_i32 s51, s51, 1024
    s_add_u32 s51, s51, s59
    s_add_u32 s52, s89, 3
    s_cmp_ge_u32 s52, 5
    s_cselect_b32 s61, 5, 0
    s_sub_u32 s52, s52, s61
    s_mul_i32 s52, s52, 1024
    s_add_u32 s52, s52, s59
    s_add_u32 s53, s89, 4
    s_cmp_ge_u32 s53, 5
    s_cselect_b32 s61, 5, 0
    s_sub_u32 s53, s53, s61
    s_mul_i32 s53, s53, 1024
    s_add_u32 s53, s53, s59
    s_mul_i32 s59, s55, 1310720
    s_lshl_b32 s58, s37, 10
    s_add_u32 s59, s59, s58
    s_add_u32 s59, s59, 10944512
    s_add_u32 s40, s63, 0
    s_cmp_ge_u32 s40, 10
    s_cselect_b32 s61, 10, 0
    s_sub_u32 s40, s40, s61
    s_mul_i32 s40, s40, 131072
    s_add_u32 s40, s40, s59
    s_add_u32 s41, s63, 1
    s_cmp_ge_u32 s41, 10
    s_cselect_b32 s61, 10, 0
    s_sub_u32 s41, s41, s61
    s_mul_i32 s41, s41, 131072
    s_add_u32 s41, s41, s59
    s_add_u32 s42, s63, 2
    s_cmp_ge_u32 s42, 10
    s_cselect_b32 s61, 10, 0
    s_sub_u32 s42, s42, s61
    s_mul_i32 s42, s42, 131072
    s_add_u32 s42, s42, s59
    s_add_u32 s43, s63, 3
    s_cmp_ge_u32 s43, 10
    s_cselect_b32 s61, 10, 0
    s_sub_u32 s43, s43, s61
    s_mul_i32 s43, s43, 131072
    s_add_u32 s43, s43, s59
    s_add_u32 s44, s63, 4
    s_cmp_ge_u32 s44, 10
    s_cselect_b32 s61, 10, 0
    s_sub_u32 s44, s44, s61
    s_mul_i32 s44, s44, 131072
    s_add_u32 s44, s44, s59
    s_add_u32 s45, s63, 5
    s_cmp_ge_u32 s45, 10
    s_cselect_b32 s61, 10, 0
    s_sub_u32 s45, s45, s61
    s_mul_i32 s45, s45, 131072
    s_add_u32 s45, s45, s59
    s_add_u32 s46, s63, 6
    s_cmp_ge_u32 s46, 10
    s_cselect_b32 s61, 10, 0
    s_sub_u32 s46, s46, s61
    s_mul_i32 s46, s46, 131072
    s_add_u32 s46, s46, s59
    s_add_u32 s47, s63, 7
    s_cmp_ge_u32 s47, 10
    s_cselect_b32 s61, 10, 0
    s_sub_u32 s47, s47, s61
    s_mul_i32 s47, s47, 131072
    s_add_u32 s47, s47, s59
    s_add_u32 s48, s63, 8
    s_cmp_ge_u32 s48, 10
    s_cselect_b32 s61, 10, 0
    s_sub_u32 s48, s48, s61
    s_mul_i32 s48, s48, 131072
    s_add_u32 s48, s48, s59
    s_add_u32 s101, s63, 9
    s_cmp_ge_u32 s101, 10
    s_cselect_b32 s61, 10, 0
    s_sub_u32 s101, s101, s61
    s_mul_i32 s101, s101, 131072
    s_add_u32 s101, s101, s59
    s_add_u32 m0, s38, 0
    s_add_u32 s58, s49, s64
    buffer_load_dwordx4 v8, s[16:19], s58 offen sc1 lds
    s_add_u32 m0, s38, 1024
    s_add_u32 s58, s49, s65
    buffer_load_dwordx4 v8, s[16:19], s58 offen sc1 lds
    s_add_u32 m0, s38, 2048
    s_add_u32 s58, s49, s66
    buffer_load_dwordx4 v8, s[16:19], s58 offen sc1 lds
    s_add_u32 m0, s38, 3072
    s_add_u32 s58, s49, s67
    buffer_load_dwordx4 v8, s[16:19], s58 offen sc1 lds
    s_add_u32 m0, s38, 4096
    s_add_u32 s58, s49, s68
    buffer_load_dwordx4 v8, s[16:19], s58 offen sc1 lds
    s_add_u32 m0, s38, 5120
    s_add_u32 s58, s49, s69
    buffer_load_dwordx4 v8, s[16:19], s58 offen sc1 lds
    s_add_u32 m0, s38, 6144
    s_add_u32 s58, s49, s70
    buffer_load_dwordx4 v8, s[16:19], s58 offen sc1 lds
    s_add_u32 m0, s38, 7168
    s_add_u32 s58, s49, s71
    buffer_load_dwordx4 v8, s[16:19], s58 offen sc1 lds
    s_add_u32 m0, s38, 8192
    s_add_u32 s58, s49, s80
    buffer_load_dwordx4 v8, s[16:19], s58 offen sc1 lds
    s_add_u32 m0, s38, 9216
    s_add_u32 s58, s49, s81
    buffer_load_dwordx4 v8, s[16:19], s58 offen sc1 lds
    s_add_u32 m0, s38, 10240
    s_add_u32 s58, s50, s64
    buffer_load_dwordx4 v8, s[16:19], s58 offen sc1 lds
    s_add_u32 m0, s38, 11264
    s_add_u32 s58, s50, s65
    buffer_load_dwordx4 v8, s[16:19], s58 offen sc1 lds
    s_mul_i32 s58, s55, 640
    s_add_u32 s58, s58, 13631488
    s_mov_b32 s60, 0
Kp3z_nonce:
    v_readfirstlane_b32 s20, v6
    v_readfirstlane_b32 s21, v7
    s_nop 0
    s_cmp_lg_u32 s21, 0
    s_cbranch_scc1 Kp3z_nonceok
    s_add_u32 s60, s60, 1
    s_cmp_lt_u32 s60, 262144
    s_cbranch_scc0 Kp3z_nonceok
    v_mov_b32 v80, 0
    global_load_dwordx2 v[6:7], v80, s[84:85] sc1
    s_waitcnt vmcnt(0)
    s_branch Kp3z_nonce
Kp3z_nonceok:
    v_mul_u32_u24 v80, 32, v1
    s_mov_b32 s60, 0
    v_cmp_gt_u32 vcc, 20, v1
    s_nop 0
    s_and_saveexec_b64 s[22:23], vcc
K_poll_p3z:
    buffer_load_dwordx2 v[82:83], v80, s[16:19], s58 offen sc1
    s_waitcnt vmcnt(0)
    v_cmp_eq_u64 s[54:55], v[82:83], s[20:21]
    s_nop 0
    s_mov_b64 s[56:57], s[54:55]
    s_cmp_eq_u64 s[56:57], exec
    s_cbranch_scc1 K_pollok_p3z
    s_add_u32 s60, s60, 1
    s_cmp_lt_u32 s60, 262144
    s_cbranch_scc0 K_pollok_p3z
    s_sleep 1
    s_branch K_poll_p3z
K_pollok_p3z:
    s_mov_b64 exec, s[22:23]
    v_lshlrev_b32 v14, 16, v14
    buffer_load_dwordx4 v[80:83], v76, s[16:19], s40 offen offset:0 sc1
    buffer_load_dwordx4 v[84:87], v76, s[16:19], s40 offen offset:256 sc1
    buffer_load_dwordx4 v[88:91], v76, s[16:19], s40 offen offset:512 sc1
    buffer_load_dwordx4 v[92:95], v76, s[16:19], s40 offen offset:768 sc1
    buffer_load_dwordx4 v[96:99], v76, s[16:19], s41 offen offset:0 sc1
    buffer_load_dwordx4 v[100:103], v76, s[16:19], s41 offen offset:256 sc1
    buffer_load_dwordx4 v[104:107], v76, s[16:19], s41 offen offset:512 sc1
    buffer_load_dwordx4 v[108:111], v76, s[16:19], s41 offen offset:768 sc1
    buffer_load_dwordx4 v[112:115], v76, s[16:19], s42 offen offset:0 sc1
    buffer_load_dwordx4 v[116:119], v76, s[16:19], s42 offen offset:256 sc1
    buffer_load_dwordx4 v[120:123], v76, s[16:19], s42 offen offset:512 sc1
    buffer_load_dwordx4 v[124:127], v76, s[16:19], s42 offen offset:768 sc1
    buffer_load_dwordx4 v[128:131], v76, s[16:19], s43 offen offset:0 sc1
    buffer_load_dwordx4 v[132:135], v76, s[16:19], s43 offen offset:256 sc1
    buffer_load_dwordx4 v[136:139], v76, s[16:19], s43 offen offset:512 sc1
    buffer_load_dwordx4 v[140:143], v76, s[16:19], s43 offen offset:768 sc1
    buffer_load_dwordx4 v[144:147], v76, s[16:19], s44 offen offset:0 sc1
    buffer_load_dwordx4 v[148:151], v76, s[16:19], s44 offen offset:256 sc1
    buffer_load_dwordx4 v[152:155], v76, s[16:19], s44 offen offset:512 sc1
    buffer_load_dwordx4 v[156:159], v76, s[16:19], s44 offen offset:768 sc1
    buffer_load_dwordx4 v[160:163], v76, s[16:19], s45 offen offset:0 sc1
    buffer_load_dwordx4 v[164:167], v76, s[16:19], s45 offen offset:256 sc1
    buffer_load_dwordx4 v[168:171], v76, s[16:19], s45 offen offset:512 sc1
    buffer_load_dwordx4 v[172:175], v76, s[16:19], s45 offen offset:768 sc1
    buffer_load_dwordx4 v[176:179], v76, s[16:19], s46 offen offset:0 sc1
    buffer_load_dwordx4 v[180:183], v76, s[16:19], s46 offen offset:256 sc1
    buffer_load_dwordx4 v[184:187], v76, s[16:19], s46 offen offset:512 sc1
    buffer_load_dwordx4 v[188:191], v76, s[16:19], s46 offen offset:768 sc1
    buffer_load_dwordx4 v[192:195], v76, s[16:19], s47 offen offset:0 sc1
    buffer_load_dwordx4 v[196:199], v76, s[16:19], s47 offen offset:256 sc1
    buffer_load_dwordx4 v[200:203], v76, s[16:19], s47 offen offset:512 sc1
    buffer_load_dwordx4 v[204:207], v76, s[16:19], s47 offen offset:768 sc1
    buffer_load_dwordx4 v[208:211], v76, s[16:19], s48 offen offset:0 sc1
    buffer_load_dwordx4 v[212:215], v76, s[16:19], s48 offen offset:256 sc1
    buffer_load_dwordx4 v[216:219], v76, s[16:19], s48 offen offset:512 sc1
    buffer_load_dwordx4 v[220:223], v76, s[16:19], s48 offen offset:768 sc1
    buffer_load_dwordx4 v[224:227], v76, s[16:19], s101 offen offset:0 sc1
    buffer_load_dwordx4 v[228:231], v76, s[16:19], s101 offen offset:256 sc1
    buffer_load_dwordx4 v[232:235], v76, s[16:19], s101 offen offset:512 sc1
    buffer_load_dwordx4 v[236:239], v76, s[16:19], s101 offen offset:768 sc1
    ds_read_b128 v[240:243], v77
    s_waitcnt vmcnt(36)
    ds_read_b128 v[244:247], v77 offset:1024
    s_waitcnt lgkmcnt(1)
    v_mfma_f32_16x16x32_bf16 v[44:47], v[240:243], v[80:83], 0
    v_mfma_f32_16x16x32_bf16 v[48:51], v[240:243], v[84:87], 0
    v_mfma_f32_16x16x32_bf16 v[52:55], v[240:243], v[88:91], 0
    v_mfma_f32_16x16x32_bf16 v[56:59], v[240:243], v[92:95], 0
    s_add_u32 m0, s38, 0
    s_add_u32 s58, s50, s66
    buffer_load_dwordx4 v8, s[16:19], s58 offen sc1 lds
    s_waitcnt vmcnt(32)
    ds_read_b128 v[240:243], v77 offset:2048
    s_waitcnt lgkmcnt(1)
    v_mfma_f32_16x16x32_bf16 v[44:47], v[244:247], v[96:99], v[44:47]
    v_mfma_f32_16x16x32_bf16 v[48:51], v[244:247], v[100:103], v[48:51]
    v_mfma_f32_16x16x32_bf16 v[52:55], v[244:247], v[104:107], v[52:55]
    v_mfma_f32_16x16x32_bf16 v[56:59], v[244:247], v[108:111], v[56:59]
    s_add_u32 m0, s38, 1024
    s_add_u32 s58, s50, s67
    buffer_load_dwordx4 v8, s[16:19], s58 offen sc1 lds
    s_waitcnt vmcnt(28)
    ds_read_b128 v[244:247], v77 offset:3072
    s_waitcnt lgkmcnt(1)
    v_mfma_f32_16x16x32_bf16 v[44:47], v[240:243], v[112:115], v[44:47]
    v_mfma_f32_16x16x32_bf16 v[48:51], v[240:243], v[116:119], v[48:51]
    v_mfma_f32_16x16x32_bf16 v[52:55], v[240:243], v[120:123], v[52:55]
    v_mfma_f32_16x16x32_bf16 v[56:59], v[240:243], v[124:127], v[56:59]
    s_add_u32 m0, s38, 2048
    s_add_u32 s58, s50, s68
    buffer_load_dwordx4 v8, s[16:19], s58 offen sc1 lds
    s_waitcnt vmcnt(24)
    ds_read_b128 v[240:243], v77 offset:4096
    s_waitcnt lgkmcnt(1)
    v_mfma_f32_16x16x32_bf16 v[44:47], v[244:247], v[128:131], v[44:47]
    v_mfma_f32_16x16x32_bf16 v[48:51], v[244:247], v[132:135], v[48:51]
    v_mfma_f32_16x16x32_bf16 v[52:55], v[244:247], v[136:139], v[52:55]
    v_mfma_f32_16x16x32_bf16 v[56:59], v[244:247], v[140:143], v[56:59]
    s_add_u32 m0, s38, 3072
    s_add_u32 s58, s50, s69
    buffer_load_dwordx4 v8, s[16:19], s58 offen sc1 lds
    s_waitcnt vmcnt(20)
    ds_read_b128 v[244:247], v77 offset:5120
    s_waitcnt lgkmcnt(1)
    v_mfma_f32_16x16x32_bf16 v[44:47], v[240:243], v[144:147], v[44:47]
    v_mfma_f32_16x16x32_bf16 v[48:51], v[240:243], v[148:151], v[48:51]
    v_mfma_f32_16x16x32_bf16 v[52:55], v[240:243], v[152:155], v[52:55]
    v_mfma_f32_16x16x32_bf16 v[56:59], v[240:243], v[156:159], v[56:59]
    s_add_u32 m0, s38, 4096
    s_add_u32 s58, s50, s70
    buffer_load_dwordx4 v8, s[16:19], s58 offen sc1 lds
    s_waitcnt vmcnt(16)
    ds_read_b128 v[240:243], v77 offset:6144
    s_waitcnt lgkmcnt(1)
    v_mfma_f32_16x16x32_bf16 v[44:47], v[244:247], v[160:163], v[44:47]
    v_mfma_f32_16x16x32_bf16 v[48:51], v[244:247], v[164:167], v[48:51]
    v_mfma_f32_16x16x32_bf16 v[52:55], v[244:247], v[168:171], v[52:55]
    v_mfma_f32_16x16x32_bf16 v[56:59], v[244:247], v[172:175], v[56:59]
    s_add_u32 m0, s38, 5120
    s_add_u32 s58, s50, s71
    buffer_load_dwordx4 v8, s[16:19], s58 offen sc1 lds
    s_waitcnt vmcnt(12)
    ds_read_b128 v[244:247], v77 offset:7168
    s_waitcnt lgkmcnt(1)
    v_mfma_f32_16x16x32_bf16 v[44:47], v[240:243], v[176:179], v[44:47]
    v_mfma_f32_16x16x32_bf16 v[48:51], v[240:243], v[180:183], v[48:51]
    v_mfma_f32_16x16x32_bf16 v[52:55], v[240:243], v[184:187], v[52:55]
    v_mfma_f32_16x16x32_bf16 v[56:59], v[240:243], v[188:191], v[56:59]
    s_add_u32 m0, s38, 6144
    s_add_u32 s58, s50, s80
    buffer_load_dwordx4 v8, s[16:19], s58 offen sc1 lds
    s_waitcnt vmcnt(8)
    ds_read_b128 v[240:243], v77 offset:8192
    s_waitcnt lgkmcnt(1)
    v_mfma_f32_16x16x32_bf16 v[44:47], v[244:247], v[192:195], v[44:47]
    v_mfma_f32_16x16x32_bf16 v[48:51], v[244:247], v[196:199], v[48:51]
    v_mfma_f32_16x16x32_bf16 v[52:55], v[244:247], v[200:203], v[52:55]
    v_mfma_f32_16x16x32_bf16 v[56:59], v[244:247], v[204:207], v[56:59]
    s_add_u32 m0, s38, 7168
    s_add_u32 s58, s50, s81
    buffer_load_dwordx4 v8, s[16:19], s58 offen sc1 lds
    s_waitcnt vmcnt(4)
    ds_read_b128 v[244:247], v77 offset:9216
    s_waitcnt lgkmcnt(1)
    v_mfma_f32_16x16x32_bf16 v[44:47], v[240:243], v[208:211], v[44:47]
    v_mfma_f32_16x16x32_bf16 v[48:51], v[240:243], v[212:215], v[48:51]
    v_mfma_f32_16x16x32_bf16 v[52:55], v[240:243], v[216:219], v[52:55]
    v_mfma_f32_16x16x32_bf16 v[56:59], v[240:243], v[220:223], v[56:59]
    s_add_u32 m0, s38, 8192
    s_add_u32 s58, s51, s64
    buffer_load_dwordx4 v8, s[16:19], s58 offen sc1 lds
    s_waitcnt vmcnt(0)
    ds_read_b128 v[240:243], v77 offset:10240
    s_waitcnt lgkmcnt(1)
    v_mfma_f32_16x16x32_bf16 v[44:47], v[244:247], v[224:227], v[44:47]
    v_mfma_f32_16x16x32_bf16 v[48:51], v[244:247], v[228:231], v[48:51]
    v_mfma_f32_16x16x32_bf16 v[52:55], v[244:247], v[232:235], v[52:55]
    v_mfma_f32_16x16x32_bf16 v[56:59], v[244:247], v[236:239], v[56:59]
    s_add_u32 m0, s38, 9216
    s_add_u32 s58, s51, s65
    buffer_load_dwordx4 v8, s[16:19], s58 offen sc1 lds
    ds_read_b128 v[244:247], v77 offset:11264
    s_waitcnt lgkmcnt(1)
    v_mfma_f32_16x16x32_bf16 v[60:63], v[240:243], v[80:83], 0
    v_mfma_f32_16x16x32_bf16 v[64:67], v[240:243], v[84:87], 0
    v_mfma_f32_16x16x32_bf16 v[68:71], v[240:243], v[88:91], 0
    v_mfma_f32_16x16x32_bf16 v[72:75], v[240:243], v[92:95], 0
    s_add_u32 m0, s38, 10240
    s_add_u32 s58, s51, s66
    buffer_load_dwordx4 v8, s[16:19], s58 offen sc1 lds
    s_waitcnt vmcnt(10)
    ds_read_b128 v[240:243], v77 offset:0
    s_waitcnt lgkmcnt(1)
    v_mfma_f32_16x16x32_bf16 v[60:63], v[244:247], v[96:99], v[60:63]
    v_mfma_f32_16x16x32_bf16 v[64:67], v[244:247], v[100:103], v[64:67]
    v_mfma_f32_16x16x32_bf16 v[68:71], v[244:247], v[104:107], v[68:71]
    v_mfma_f32_16x16x32_bf16 v[72:75], v[244:247], v[108:111], v[72:75]
    s_add_u32 m0, s38, 11264
    s_add_u32 s58, s51, s67
    buffer_load_dwordx4 v8, s[16:19], s58 offen sc1 lds
    s_waitcnt vmcnt(10)
    ds_read_b128 v[244:247], v77 offset:1024
    s_waitcnt lgkmcnt(1)
    v_mfma_f32_16x16x32_bf16 v[60:63], v[240:243], v[112:115], v[60:63]
    ds_write_b128 v9, v[44:47] offset:0
    ds_write_b128 v9, v[48:51] offset:1024
    v_mfma_f32_16x16x32_bf16 v[64:67], v[240:243], v[116:119], v[64:67]
    ds_write_b128 v9, v[52:55] offset:2048
    ds_write_b128 v9, v[56:59] offset:3072
    v_mfma_f32_16x16x32_bf16 v[68:71], v[240:243], v[120:123], v[68:71]
    v_mfma_f32_16x16x32_bf16 v[72:75], v[240:243], v[124:127], v[72:75]
    s_add_u32 m0, s38, 0
    s_add_u32 s58, s51, s68
    buffer_load_dwordx4 v8, s[16:19], s58 offen sc1 lds
    s_waitcnt vmcnt(10)
    ds_read_b128 v[240:243], v77 offset:2048
    s_waitcnt lgkmcnt(1)
    v_mfma_f32_16x16x32_bf16 v[60:63], v[244:247], v[128:131], v[60:63]
    s_waitcnt lgkmcnt(0)
    s_barrier
    v_mfma_f32_16x16x32_bf16 v[64:67], v[244:247], v[132:135], v[64:67]
    ds_read2st64_b64 v[22:25], v10 offset0:0 offset1:8
    ds_read2st64_b64 v[26:29], v10 offset0:16 offset1:24
    v_mfma_f32_16x16x32_bf16 v[68:71], v[244:247], v[136:139], v[68:71]
    ds_read2st64_b64 v[30:33], v10 offset0:32 offset1:40
    ds_read2st64_b64 v[34:37], v10 offset0:48 offset1:56
    v_mfma_f32_16x16x32_bf16 v[72:75], v[244:247], v[140:143], v[72:75]
    v_add_u32 v15, s96, v11
    s_add_u32 m0, s38, 1024
    s_add_u32 s58, s51, s69
    buffer_load_dwordx4 v8, s[16:19], s58 offen sc1 lds
    s_waitcnt vmcnt(10)
    ds_read_b128 v[244:247], v77 offset:3072
    s_waitcnt lgkmcnt(1)
    v_mfma_f32_16x16x32_bf16 v[60:63], v[240:243], v[144:147], v[60:63]
    v_mfma_f32_16x16x32_bf16 v[64:67], v[240:243], v[148:151], v[64:67]
    v_mfma_f32_16x16x32_bf16 v[68:71], v[240:243], v[152:155], v[68:71]
    v_mfma_f32_16x16x32_bf16 v[72:75], v[240:243], v[156:159], v[72:75]
    s_add_u32 m0, s38, 2048
    s_add_u32 s58, s51, s70
    buffer_load_dwordx4 v8, s[16:19], s58 offen sc1 lds
    s_waitcnt vmcnt(10)
    ds_read_b128 v[240:243], v77 offset:4096
    s_waitcnt lgkmcnt(1)
    v_mfma_f32_16x16x32_bf16 v[60:63], v[244:247], v[160:163], v[60:63]
    s_waitcnt lgkmcnt(0)
    v_add_f32 v22, v22, v24
    v_mfma_f32_16x16x32_bf16 v[64:67], v[244:247], v[164:167], v[64:67]
    v_add_f32 v23, v23, v25
    v_add_f32 v26, v26, v28
    v_mfma_f32_16x16x32_bf16 v[68:71], v[244:247], v[168:171], v[68:71]
    v_add_f32 v27, v27, v29
    v_add_f32 v30, v30, v32
    v_mfma_f32_16x16x32_bf16 v[72:75], v[244:247], v[172:175], v[72:75]
    v_add_f32 v31, v31, v33
    v_add_f32 v34, v34, v36
    s_add_u32 m0, s38, 3072
    s_add_u32 s58, s51, s71
    buffer_load_dwordx4 v8, s[16:19], s58 offen sc1 lds
    s_waitcnt vmcnt(10)
    ds_read_b128 v[244:247], v77 offset:5120
    s_waitcnt lgkmcnt(1)
    v_mfma_f32_16x16x32_bf16 v[60:63], v[240:243], v[176:179], v[60:63]
    v_add_f32 v35, v35, v37
    v_add_f32 v22, v22, v26
    v_mfma_f32_16x16x32_bf16 v[64:67], v[240:243], v[180:183], v[64:67]
    v_add_f32 v23, v23, v27
    v_add_f32 v22, v22, v30
    v_mfma_f32_16x16x32_bf16 v[68:71], v[240:243], v[184:187], v[68:71]
    v_add_f32 v23, v23, v31
    v_add_f32 v22, v22, v14
    v_mfma_f32_16x16x32_bf16 v[72:75], v[240:243], v[188:191], v[72:75]
    v_add_f32 v23, v23, v14
    v_mul_f32 v38, v22, v13
    s_add_u32 m0, s38, 4096
    s_add_u32 s58, s51, s80
    buffer_load_dwordx4 v8, s[16:19], s58 offen sc1 lds
    s_waitcnt vmcnt(10)
    ds_read_b128 v[240:243], v77 offset:6144
    s_waitcnt lgkmcnt(1)
    v_mfma_f32_16x16x32_bf16 v[60:63], v[244:247], v[192:195], v[60:63]
    v_mul_f32 v39, v23, v13
    v_fmac_f32 v38, v34, v12
    v_mfma_f32_16x16x32_bf16 v[64:67], v[244:247], v[196:199], v[64:67]
    v_fmac_f32 v39, v35, v12
    v_cvt_pk_bf16_f32 v40, v38, v39
    v_mfma_f32_16x16x32_bf16 v[68:71], v[244:247], v[200:203], v[68:71]
    ds_write_b32 v15, v40
    v_mfma_f32_16x16x32_bf16 v[72:75], v[244:247], v[204:207], v[72:75]
    s_add_u32 m0, s38, 5120
    s_add_u32 s58, s51, s81
    buffer_load_dwordx4 v8, s[16:19], s58 offen sc1 lds
    s_waitcnt vmcnt(10)
    ds_read_b128 v[244:247], v77 offset:7168
    s_waitcnt lgkmcnt(1)
    v_mfma_f32_16x16x32_bf16 v[60:63], v[240:243], v[208:211], v[60:63]
    v_mfma_f32_16x16x32_bf16 v[64:67], v[240:243], v[212:215], v[64:67]
    v_mfma_f32_16x16x32_bf16 v[68:71], v[240:243], v[216:219], v[68:71]
    v_mfma_f32_16x16x32_bf16 v[72:75], v[240:243], v[220:223], v[72:75]
    s_add_u32 m0, s38, 6144
    s_add_u32 s58, s52, s64
    buffer_load_dwordx4 v8, s[16:19], s58 offen sc1 lds
    s_waitcnt vmcnt(10)
    ds_read_b128 v[240:243], v77 offset:8192
    s_waitcnt lgkmcnt(1)
    v_mfma_f32_16x16x32_bf16 v[60:63], v[244:247], v[224:227], v[60:63]
    v_mfma_f32_16x16x32_bf16 v[64:67], v[244:247], v[228:231], v[64:67]
    v_mfma_f32_16x16x32_bf16 v[68:71], v[244:247], v[232:235], v[68:71]
    v_mfma_f32_16x16x32_bf16 v[72:75], v[244:247], v[236:239], v[72:75]
    s_add_u32 m0, s38, 7168
    s_add_u32 s58, s52, s65
    buffer_load_dwordx4 v8, s[16:19], s58 offen sc1 lds
    s_waitcnt vmcnt(10)
    ds_read_b128 v[244:247], v77 offset:9216
    s_waitcnt lgkmcnt(1)
    v_mfma_f32_16x16x32_bf16 v[44:47], v[240:243], v[80:83], 0
    v_mfma_f32_16x16x32_bf16 v[48:51], v[240:243], v[84:87], 0
    v_mfma_f32_16x16x32_bf16 v[52:55], v[240:243], v[88:91], 0
    v_mfma_f32_16x16x32_bf16 v[56:59], v[240:243], v[92:95], 0
    s_add_u32 m0, s38, 8192
    s_add_u32 s58, s52, s66
    buffer_load_dwordx4 v8, s[16:19], s58 offen sc1 lds
    s_waitcnt vmcnt(10)
    ds_read_b128 v[240:243], v77 offset:10240
    s_waitcnt lgkmcnt(1)
    v_mfma_f32_16x16x32_bf16 v[44:47], v[244:247], v[96:99], v[44:47]
    v_mfma_f32_16x16x32_bf16 v[48:51], v[244:247], v[100:103], v[48:51]
    v_mfma_f32_16x16x32_bf16 v[52:55], v[244:247], v[104:107], v[52:55]
    v_mfma_f32_16x16x32_bf16 v[56:59], v[244:247], v[108:111], v[56:59]
    s_add_u32 m0, s38, 9216
    s_add_u32 s58, s52, s67
    buffer_load_dwordx4 v8, s[16:19], s58 offen sc1 lds
    s_waitcnt vmcnt(10)
    ds_read_b128 v[244:247], v77 offset:11264
    s_waitcnt lgkmcnt(1)
    v_mfma_f32_16x16x32_bf16 v[44:47], v[240:243], v[112:115], v[44:47]
    ds_write_b128 v9, v[60:63] offset:32768
    ds_write_b128 v9, v[64:67] offset:33792
    v_mfma_f32_16x16x32_bf16 v[48:51], v[240:243], v[116:119], v[48:51]
    ds_write_b128 v9, v[68:71] offset:34816
    ds_write_b128 v9, v[72:75] offset:35840
    v_mfma_f32_16x16x32_bf16 v[52:55], v[240:243], v[120:123], v[52:55]
    v_mfma_f32_16x16x32_bf16 v[56:59], v[240:243], v[124:127], v[56:59]
    s_add_u32 m0, s38, 10240
    s_add_u32 s58, s52, s68
    buffer_load_dwordx4 v8, s[16:19], s58 offen sc1 lds
    s_waitcnt vmcnt(10)
    ds_read_b128 v[240:243], v77 offset:0
    s_waitcnt lgkmcnt(1)
    v_mfma_f32_16x16x32_bf16 v[44:47], v[244:247], v[128:131], v[44:47]
    s_waitcnt lgkmcnt(0)
    s_barrier
    v_mfma_f32_16x16x32_bf16 v[48:51], v[244:247], v[132:135], v[48:51]
    ds_read2st64_b64 v[22:25], v10 offset0:64 offset1:72
    ds_read2st64_b64 v[26:29], v10 offset0:80 offset1:88
    v_mfma_f32_16x16x32_bf16 v[52:55], v[244:247], v[136:139], v[52:55]
    ds_read2st64_b64 v[30:33], v10 offset0:96 offset1:104
    ds_read2st64_b64 v[34:37], v10 offset0:112 offset1:120
    v_mfma_f32_16x16x32_bf16 v[56:59], v[244:247], v[140:143], v[56:59]
    v_add_u32 v15, s97, v11
    s_add_u32 m0, s38, 11264
    s_add_u32 s58, s52, s69
    buffer_load_dwordx4 v8, s[16:19], s58 offen sc1 lds
    s_waitcnt vmcnt(10)
    ds_read_b128 v[244:247], v77 offset:1024
    s_waitcnt lgkmcnt(1)
    v_mfma_f32_16x16x32_bf16 v[44:47], v[240:243], v[144:147], v[44:47]
    v_mfma_f32_16x16x32_bf16 v[48:51], v[240:243], v[148:151], v[48:51]
    v_mfma_f32_16x16x32_bf16 v[52:55], v[240:243], v[152:155], v[52:55]
    v_mfma_f32_16x16x32_bf16 v[56:59], v[240:243], v[156:159], v[56:59]
    s_add_u32 m0, s38, 0
    s_add_u32 s58, s52, s70
    buffer_load_dwordx4 v8, s[16:19], s58 offen sc1 lds
    s_waitcnt vmcnt(10)
    ds_read_b128 v[240:243], v77 offset:2048
    s_waitcnt lgkmcnt(1)
    v_mfma_f32_16x16x32_bf16 v[44:47], v[244:247], v[160:163], v[44:47]
    s_waitcnt lgkmcnt(0)
    v_add_f32 v22, v22, v24
    v_mfma_f32_16x16x32_bf16 v[48:51], v[244:247], v[164:167], v[48:51]
    v_add_f32 v23, v23, v25
    v_add_f32 v26, v26, v28
    v_mfma_f32_16x16x32_bf16 v[52:55], v[244:247], v[168:171], v[52:55]
    v_add_f32 v27, v27, v29
    v_add_f32 v30, v30, v32
    v_mfma_f32_16x16x32_bf16 v[56:59], v[244:247], v[172:175], v[56:59]
    v_add_f32 v31, v31, v33
    v_add_f32 v34, v34, v36
    s_add_u32 m0, s38, 1024
    s_add_u32 s58, s52, s71
    buffer_load_dwordx4 v8, s[16:19], s58 offen sc1 lds
    s_waitcnt vmcnt(10)
    ds_read_b128 v[244:247], v77 offset:3072
    s_waitcnt lgkmcnt(1)
    v_mfma_f32_16x16x32_bf16 v[44:47], v[240:243], v[176:179], v[44:47]
    v_add_f32 v35, v35, v37
    v_add_f32 v22, v22, v26
    v_mfma_f32_16x16x32_bf16 v[48:51], v[240:243], v[180:183], v[48:51]
    v_add_f32 v23, v23, v27
    v_add_f32 v22, v22, v30
    v_mfma_f32_16x16x32_bf16 v[52:55], v[240:243], v[184:187], v[52:55]
    v_add_f32 v23, v23, v31
    v_add_f32 v22, v22, v14
    v_mfma_f32_16x16x32_bf16 v[56:59], v[240:243], v[188:191], v[56:59]
    v_add_f32 v23, v23, v14
    v_mul_f32 v38, v22, v13
    s_add_u32 m0, s38, 2048
    s_add_u32 s58, s52, s80
    buffer_load_dwordx4 v8, s[16:19], s58 offen sc1 lds
    s_waitcnt vmcnt(10)
    ds_read_b128 v[240:243], v77 offset:4096
    s_waitcnt lgkmcnt(1)
    v_mfma_f32_16x16x32_bf16 v[44:47], v[244:247], v[192:195], v[44:47]
    v_mul_f32 v39, v23, v13
    v_fmac_f32 v38, v34, v12
    v_mfma_f32_16x16x32_bf16 v[48:51], v[244:247], v[196:199], v[48:51]
    v_fmac_f32 v39, v35, v12
    v_cvt_pk_bf16_f32 v40, v38, v39
    v_mfma_f32_16x16x32_bf16 v[52:55], v[244:247], v[200:203], v[52:55]
    ds_write_b32 v15, v40
    v_mfma_f32_16x16x32_bf16 v[56:59], v[244:247], v[204:207], v[56:59]
    s_add_u32 m0, s38, 3072
    s_add_u32 s58, s52, s81
    buffer_load_dwordx4 v8, s[16:19], s58 offen sc1 lds
    s_waitcnt vmcnt(10)
    ds_read_b128 v[244:247], v77 offset:5120
    s_waitcnt lgkmcnt(1)
    v_mfma_f32_16x16x32_bf16 v[44:47], v[240:243], v[208:211], v[44:47]
    v_mfma_f32_16x16x32_bf16 v[48:51], v[240:243], v[212:215], v[48:51]
    v_mfma_f32_16x16x32_bf16 v[52:55], v[240:243], v[216:219], v[52:55]
    v_mfma_f32_16x16x32_bf16 v[56:59], v[240:243], v[220:223], v[56:59]
    s_add_u32 m0, s38, 4096
    s_add_u32 s58, s53, s64
    buffer_load_dwordx4 v8, s[16:19], s58 offen sc1 lds
    s_waitcnt vmcnt(10)
    ds_read_b128 v[240:243], v77 offset:6144
    s_waitcnt lgkmcnt(1)
    v_mfma_f32_16x16x32_bf16 v[44:47], v[244:247], v[224:227], v[44:47]
    v_mfma_f32_16x16x32_bf16 v[48:51], v[244:247], v[228:231], v[48:51]
    v_mfma_f32_16x16x32_bf16 v[52:55], v[244:247], v[232:235], v[52:55]
    v_mfma_f32_16x16x32_bf16 v[56:59], v[244:247], v[236:239], v[56:59]
    s_add_u32 m0, s38, 5120
    s_add_u32 s58, s53, s65
    buffer_load_dwordx4 v8, s[16:19], s58 offen sc1 lds
    s_waitcnt vmcnt(10)
    ds_read_b128 v[244:247], v77 offset:7168
    s_waitcnt lgkmcnt(1)
    v_mfma_f32_16x16x32_bf16 v[60:63], v[240:243], v[80:83], 0
    v_mfma_f32_16x16x32_bf16 v[64:67], v[240:243], v[84:87], 0
    v_mfma_f32_16x16x32_bf16 v[68:71], v[240:243], v[88:91], 0
    v_mfma_f32_16x16x32_bf16 v[72:75], v[240:243], v[92:95], 0
    s_add_u32 m0, s38, 6144
    s_add_u32 s58, s53, s66
    buffer_load_dwordx4 v8, s[16:19], s58 offen sc1 lds
    s_waitcnt vmcnt(10)
    ds_read_b128 v[240:243], v77 offset:8192
    s_waitcnt lgkmcnt(1)
    v_mfma_f32_16x16x32_bf16 v[60:63], v[244:247], v[96:99], v[60:63]
    v_mfma_f32_16x16x32_bf16 v[64:67], v[244:247], v[100:103], v[64:67]
    v_mfma_f32_16x16x32_bf16 v[68:71], v[244:247], v[104:107], v[68:71]
    v_mfma_f32_16x16x32_bf16 v[72:75], v[244:247], v[108:111], v[72:75]
    s_add_u32 m0, s38, 7168
    s_add_u32 s58, s53, s67
    buffer_load_dwordx4 v8, s[16:19], s58 offen sc1 lds
    s_waitcnt vmcnt(10)
    ds_read_b128 v[244:247], v77 offset:9216
    s_waitcnt lgkmcnt(1)
    v_mfma_f32_16x16x32_bf16 v[60:63], v[240:243], v[112:115], v[60:63]
    ds_write_b128 v9, v[44:47] offset:0
    ds_write_b128 v9, v[48:51] offset:1024
    v_mfma_f32_16x16x32_bf16 v[64:67], v[240:243], v[116:119], v[64:67]
    ds_write_b128 v9, v[52:55] offset:2048
    ds_write_b128 v9, v[56:59] offset:3072
    v_mfma_f32_16x16x32_bf16 v[68:71], v[240:243], v[120:123], v[68:71]
    v_mfma_f32_16x16x32_bf16 v[72:75], v[240:243], v[124:127], v[72:75]
    s_add_u32 m0, s38, 8192
    s_add_u32 s58, s53, s68
    buffer_load_dwordx4 v8, s[16:19], s58 offen sc1 lds
    s_waitcnt vmcnt(10)
    ds_read_b128 v[240:243], v77 offset:10240
    s_waitcnt lgkmcnt(1)
    v_mfma_f32_16x16x32_bf16 v[60:63], v[244:247], v[128:131], v[60:63]
    s_waitcnt lgkmcnt(0)
    s_barrier
    v_mfma_f32_16x16x32_bf16 v[64:67], v[244:247], v[132:135], v[64:67]
    ds_read2st64_b64 v[22:25], v10 offset0:0 offset1:8
    ds_read2st64_b64 v[26:29], v10 offset0:16 offset1:24
    v_mfma_f32_16x16x32_bf16 v[68:71], v[244:247], v[136:139], v[68:71]
    ds_read2st64_b64 v[30:33], v10 offset0:32 offset1:40
    ds_read2st64_b64 v[34:37], v10 offset0:48 offset1:56
    v_mfma_f32_16x16x32_bf16 v[72:75], v[244:247], v[140:143], v[72:75]
    v_add_u32 v15, s98, v11
    s_add_u32 m0, s38, 9216
    s_add_u32 s58, s53, s69
    buffer_load_dwordx4 v8, s[16:19], s58 offen sc1 lds
    s_waitcnt vmcnt(10)
    ds_read_b128 v[244:247], v77 offset:11264
    s_waitcnt lgkmcnt(1)
    v_mfma_f32_16x16x32_bf16 v[60:63], v[240:243], v[144:147], v[60:63]
    v_mfma_f32_16x16x32_bf16 v[64:67], v[240:243], v[148:151], v[64:67]
    v_mfma_f32_16x16x32_bf16 v[68:71], v[240:243], v[152:155], v[68:71]
    v_mfma_f32_16x16x32_bf16 v[72:75], v[240:243], v[156:159], v[72:75]
    s_add_u32 m0, s38, 10240
    s_add_u32 s58, s53, s70
    buffer_load_dwordx4 v8, s[16:19], s58 offen sc1 lds
    s_waitcnt vmcnt(10)
    ds_read_b128 v[240:243], v77 offset:0
    s_waitcnt lgkmcnt(1)
    v_mfma_f32_16x16x32_bf16 v[60:63], v[244:247], v[160:163], v[60:63]
    s_waitcnt lgkmcnt(0)
    v_add_f32 v22, v22, v24
    v_mfma_f32_16x16x32_bf16 v[64:67], v[244:247], v[164:167], v[64:67]
    v_add_f32 v23, v23, v25
    v_add_f32 v26, v26, v28
    v_mfma_f32_16x16x32_bf16 v[68:71], v[244:247], v[168:171], v[68:71]
    v_add_f32 v27, v27, v29
    v_add_f32 v30, v30, v32
    v_mfma_f32_16x16x32_bf16 v[72:75], v[244:247], v[172:175], v[72:75]
    v_add_f32 v31, v31, v33
    v_add_f32 v34, v34, v36
    s_add_u32 m0, s38, 11264
    s_add_u32 s58, s53, s71
    buffer_load_dwordx4 v8, s[16:19], s58 offen sc1 lds
    s_waitcnt vmcnt(10)
    ds_read_b128 v[244:247], v77 offset:1024
    s_waitcnt lgkmcnt(1)
    v_mfma_f32_16x16x32_bf16 v[60:63], v[240:243], v[176:179], v[60:63]
    v_add_f32 v35, v35, v37
    v_add_f32 v22, v22, v26
    v_mfma_f32_16x16x32_bf16 v[64:67], v[240:243], v[180:183], v[64:67]
    v_add_f32 v23, v23, v27
    v_add_f32 v22, v22, v30
    v_mfma_f32_16x16x32_bf16 v[68:71], v[240:243], v[184:187], v[68:71]
    v_add_f32 v23, v23, v31
    v_add_f32 v22, v22, v14
    v_mfma_f32_16x16x32_bf16 v[72:75], v[240:243], v[188:191], v[72:75]
    v_add_f32 v23, v23, v14
    v_mul_f32 v38, v22, v13
    s_add_u32 m0, s38, 0
    s_add_u32 s58, s53, s80
    buffer_load_dwordx4 v8, s[16:19], s58 offen sc1 lds
    s_waitcnt vmcnt(10)
    ds_read_b128 v[240:243], v77 offset:2048
    s_waitcnt lgkmcnt(1)
    v_mfma_f32_16x16x32_bf16 v[60:63], v[244:247], v[192:195], v[60:63]
    v_mul_f32 v39, v23, v13
    v_fmac_f32 v38, v34, v12
    v_mfma_f32_16x16x32_bf16 v[64:67], v[244:247], v[196:199], v[64:67]
    v_fmac_f32 v39, v35, v12
    v_cvt_pk_bf16_f32 v40, v38, v39
    v_mfma_f32_16x16x32_bf16 v[68:71], v[244:247], v[200:203], v[68:71]
    ds_write_b32 v15, v40
    v_mfma_f32_16x16x32_bf16 v[72:75], v[244:247], v[204:207], v[72:75]
    s_add_u32 m0, s38, 1024
    s_add_u32 s58, s53, s81
    buffer_load_dwordx4 v8, s[16:19], s58 offen sc1 lds
    s_waitcnt vmcnt(10)
    ds_read_b128 v[244:247], v77 offset:3072
    s_waitcnt lgkmcnt(1)
    v_mfma_f32_16x16x32_bf16 v[60:63], v[240:243], v[208:211], v[60:63]
    v_mfma_f32_16x16x32_bf16 v[64:67], v[240:243], v[212:215], v[64:67]
    v_mfma_f32_16x16x32_bf16 v[68:71], v[240:243], v[216:219], v[68:71]
    v_mfma_f32_16x16x32_bf16 v[72:75], v[240:243], v[220:223], v[72:75]
    s_waitcnt vmcnt(9)
    ds_read_b128 v[240:243], v77 offset:4096
    s_waitcnt lgkmcnt(1)
    v_mfma_f32_16x16x32_bf16 v[60:63], v[244:247], v[224:227], v[60:63]
    v_mfma_f32_16x16x32_bf16 v[64:67], v[244:247], v[228:231], v[64:67]
    v_mfma_f32_16x16x32_bf16 v[68:71], v[244:247], v[232:235], v[68:71]
    v_mfma_f32_16x16x32_bf16 v[72:75], v[244:247], v[236:239], v[72:75]
    s_waitcnt vmcnt(8)
    ds_read_b128 v[244:247], v77 offset:5120
    s_waitcnt lgkmcnt(1)
    v_mfma_f32_16x16x32_bf16 v[44:47], v[240:243], v[80:83], 0
    v_mfma_f32_16x16x32_bf16 v[48:51], v[240:243], v[84:87], 0
    v_mfma_f32_16x16x32_bf16 v[52:55], v[240:243], v[88:91], 0
    v_mfma_f32_16x16x32_bf16 v[56:59], v[240:243], v[92:95], 0
    s_waitcnt vmcnt(7)
    ds_read_b128 v[240:243], v77 offset:6144
    s_waitcnt lgkmcnt(1)
    v_mfma_f32_16x16x32_bf16 v[44:47], v[244:247], v[96:99], v[44:47]
    v_mfma_f32_16x16x32_bf16 v[48:51], v[244:247], v[100:103], v[48:51]
    v_mfma_f32_16x16x32_bf16 v[52:55], v[244:247], v[104:107], v[52:55]
    v_mfma_f32_16x16x32_bf16 v[56:59], v[244:247], v[108:111], v[56:59]
    s_waitcnt vmcnt(6)
    ds_read_b128 v[244:247], v77 offset:7168
    s_waitcnt lgkmcnt(1)
    v_mfma_f32_16x16x32_bf16 v[44:47], v[240:243], v[112:115], v[44:47]
    ds_write_b128 v9, v[60:63] offset:32768
    ds_write_b128 v9, v[64:67] offset:33792
    v_mfma_f32_16x16x32_bf16 v[48:51], v[240:243], v[116:119], v[48:51]
    ds_write_b128 v9, v[68:71] offset:34816
    ds_write_b128 v9, v[72:75] offset:35840
    v_mfma_f32_16x16x32_bf16 v[52:55], v[240:243], v[120:123], v[52:55]
    v_mfma_f32_16x16x32_bf16 v[56:59], v[240:243], v[124:127], v[56:59]
    s_waitcnt vmcnt(5)
    ds_read_b128 v[240:243], v77 offset:8192
    s_waitcnt lgkmcnt(1)
    v_mfma_f32_16x16x32_bf16 v[44:47], v[244:247], v[128:131], v[44:47]
    s_waitcnt lgkmcnt(0)
    s_barrier
    v_mfma_f32_16x16x32_bf16 v[48:51], v[244:247], v[132:135], v[48:51]
    ds_read2st64_b64 v[22:25], v10 offset0:64 offset1:72
    ds_read2st64_b64 v[26:29], v10 offset0:80 offset1:88
    v_mfma_f32_16x16x32_bf16 v[52:55], v[244:247], v[136:139], v[52:55]
    ds_read2st64_b64 v[30:33], v10 offset0:96 offset1:104
    ds_read2st64_b64 v[34:37], v10 offset0:112 offset1:120
    v_mfma_f32_16x16x32_bf16 v[56:59], v[244:247], v[140:143], v[56:59]
    v_add_u32 v15, s99, v11
    s_waitcnt vmcnt(4)
    ds_read_b128 v[244:247], v77 offset:9216
    s_waitcnt lgkmcnt(1)
    v_mfma_f32_16x16x32_bf16 v[44:47], v[240:243], v[144:147], v[44:47]
    v_mfma_f32_16x16x32_bf16 v[48:51], v[240:243], v[148:151], v[48:51]
    v_mfma_f32_16x16x32_bf16 v[52:55], v[240:243], v[152:155], v[52:55]
    v_mfma_f32_16x16x32_bf16 v[56:59], v[240:243], v[156:159], v[56:59]
    s_waitcnt vmcnt(3)
    ds_read_b128 v[240:243], v77 offset:10240
    s_waitcnt lgkmcnt(1)
    v_mfma_f32_16x16x32_bf16 v[44:47], v[244:247], v[160:163], v[44:47]
    s_waitcnt lgkmcnt(0)
    v_add_f32 v22, v22, v24
    v_mfma_f32_16x16x32_bf16 v[48:51], v[244:247], v[164:167], v[48:51]
    v_add_f32 v23, v23, v25
    v_add_f32 v26, v26, v28
    v_mfma_f32_16x16x32_bf16 v[52:55], v[244:247], v[168:171], v[52:55]
    v_add_f32 v27, v27, v29
    v_add_f32 v30, v30, v32
    v_mfma_f32_16x16x32_bf16 v[56:59], v[244:247], v[172:175], v[56:59]
    v_add_f32 v31, v31, v33
    v_add_f32 v34, v34, v36
    s_waitcnt vmcnt(2)
    ds_read_b128 v[244:247], v77 offset:11264
    s_waitcnt lgkmcnt(1)
    v_mfma_f32_16x16x32_bf16 v[44:47], v[240:243], v[176:179], v[44:47]
    v_add_f32 v35, v35, v37
    v_add_f32 v22, v22, v26
    v_mfma_f32_16x16x32_bf16 v[48:51], v[240:243], v[180:183], v[48:51]
    v_add_f32 v23, v23, v27
    v_add_f32 v22, v22, v30
    v_mfma_f32_16x16x32_bf16 v[52:55], v[240:243], v[184:187], v[52:55]
    v_add_f32 v23, v23, v31
    v_add_f32 v22, v22, v14
    v_mfma_f32_16x16x32_bf16 v[56:59], v[240:243], v[188:191], v[56:59]
    v_add_f32 v23, v23, v14
    v_mul_f32 v38, v22, v13
    s_waitcnt vmcnt(1)
    ds_read_b128 v[240:243], v77 offset:0
    s_waitcnt lgkmcnt(1)
    v_mfma_f32_16x16x32_bf16 v[44:47], v[244:247], v[192:195], v[44:47]
    v_mul_f32 v39, v23, v13
    v_fmac_f32 v38, v34, v12
    v_mfma_f32_16x16x32_bf16 v[48:51], v[244:247], v[196:199], v[48:51]
    v_fmac_f32 v39, v35, v12
    v_cvt_pk_bf16_f32 v40, v38, v39
    v_mfma_f32_16x16x32_bf16 v[52:55], v[244:247], v[200:203], v[52:55]
    ds_write_b32 v15, v40
    v_mfma_f32_16x16x32_bf16 v[56:59], v[244:247], v[204:207], v[56:59]
    s_waitcnt vmcnt(0)
    ds_read_b128 v[244:247], v77 offset:1024
    s_waitcnt lgkmcnt(1)
    v_mfma_f32_16x16x32_bf16 v[44:47], v[240:243], v[208:211], v[44:47]
    v_mfma_f32_16x16x32_bf16 v[48:51], v[240:243], v[212:215], v[48:51]
    v_mfma_f32_16x16x32_bf16 v[52:55], v[240:243], v[216:219], v[52:55]
    v_mfma_f32_16x16x32_bf16 v[56:59], v[240:243], v[220:223], v[56:59]
    s_waitcnt lgkmcnt(0)
    v_mfma_f32_16x16x32_bf16 v[44:47], v[244:247], v[224:227], v[44:47]
    v_mfma_f32_16x16x32_bf16 v[48:51], v[244:247], v[228:231], v[48:51]
    v_mfma_f32_16x16x32_bf16 v[52:55], v[244:247], v[232:235], v[52:55]
    v_mfma_f32_16x16x32_bf16 v[56:59], v[244:247], v[236:239], v[56:59]
    s_nop 4
    ds_write_b128 v9, v[44:47] offset:0
    ds_write_b128 v9, v[48:51] offset:1024
    ds_write_b128 v9, v[52:55] offset:2048
    ds_write_b128 v9, v[56:59] offset:3072
    s_waitcnt lgkmcnt(0)
    s_barrier
    ds_read2st64_b64 v[22:25], v10 offset0:0 offset1:8
    ds_read2st64_b64 v[26:29], v10 offset0:16 offset1:24
    ds_read2st64_b64 v[30:33], v10 offset0:32 offset1:40
    ds_read2st64_b64 v[34:37], v10 offset0:48 offset1:56
    v_add_u32 v15, s100, v11
    s_waitcnt lgkmcnt(0)
    v_add_f32 v22, v22, v24
    v_add_f32 v23, v23, v25
    v_add_f32 v26, v26, v28
    v_add_f32 v27, v27, v29
    v_add_f32 v30, v30, v32
    v_add_f32 v31, v31, v33
    v_add_f32 v34, v34, v36
    v_add_f32 v35, v35, v37
    v_add_f32 v22, v22, v26
    v_add_f32 v23, v23, v27
    v_add_f32 v22, v22, v30
    v_add_f32 v23, v23, v31
    v_add_f32 v22, v22, v14
    v_add_f32 v23, v23, v14
    v_mul_f32 v38, v22, v13
    v_mul_f32 v39, v23, v13
    v_fmac_f32 v38, v34, v12
    v_fmac_f32 v39, v35, v12
    v_cvt_pk_bf16_f32 v40, v38, v39
    ds_write_b32 v15, v40
K_fin:
    s_waitcnt lgkmcnt(0)
    s_barrier
    s_mul_i32 s58, s37, 81920
    s_mul_i32 s59, s36, 160
    s_add_u32 s58, s58, s59
    v_add_u32 v76, 0, v0
    v_mul_u32_u24 v77, 6554, v76
    v_lshrrev_b32 v77, 16, v77
    v_mul_u32_u24 v78, 10, v77
    v_sub_u32 v78, v76, v78
    v_mul_u32_u24 v79, 176, v77
    v_lshl_add_u32 v79, v78, 4, v79
    ds_read_b128 v[84:87], v79
    v_mul_u32_u24 v80, 1280, v77
    v_lshl_add_u32 v80, v78, 4, v80
    s_waitcnt lgkmcnt(0)
    buffer_store_dwordx4 v[84:87], v80, s[24:27], s58 offen
    s_cmp_lt_u32 s3, 2
    s_cbranch_scc0 K_end
    v_add_u32 v76, 512, v0
    v_mul_u32_u24 v77, 6554, v76
    v_lshrrev_b32 v77, 16, v77
    v_mul_u32_u24 v78, 10, v77
    v_sub_u32 v78, v76, v78
    v_mul_u32_u24 v79, 176, v77
    v_lshl_add_u32 v79, v78, 4, v79
    ds_read_b128 v[84:87], v79
    v_mul_u32_u24 v80, 1280, v77
    v_lshl_add_u32 v80, v78, 4, v80
    s_waitcnt lgkmcnt(0)
    buffer_store_dwordx4 v[84:87], v80, s[24:27], s58 offen
K_end:
    s_endpgm
K_last:
.set CODE_LIMIT, K_last - K_pc - 256
.section .rodata,"a"
.p2align 6
.amdhsa_kernel gated_mix__spectral_gfnet__mixer_token_mlp__prompt_kernel
  .amdhsa_next_free_vgpr 256
  .amdhsa_next_free_sgpr 102
  .amdhsa_accum_offset 256
  .amdhsa_group_segment_fixed_size 0
  .amdhsa_kernarg_size 96
  .amdhsa_user_sgpr_count 2
  .amdhsa_user_sgpr_kernarg_segment_ptr 1
  .amdhsa_system_sgpr_workgroup_id_x 1
.end_amdhsa_kernel
```
